```python
import torch

def _softmax(x, axis=-1):
    return torch.softmax(x, dim=axis)
def _gelu(x):
    return torch.nn.functional.gelu(x, approximate="tanh")
def _silu(x):
    return torch.nn.functional.silu(x)
def _sigmoid(x):
    return torch.sigmoid(x)
def _layernorm(x, axis=-1, eps=1e-5):
    m = x.mean(dim=axis, keepdim=True)
    v = x.var(dim=axis, keepdim=True, unbiased=False)
    return (x - m) / torch.sqrt(v + eps)
def _scatter_add(tgt, idx, src, axis=0):
    return tgt.clone().index_add_(axis, idx, src)
def _segment_sum(src, seg, n):
    out = torch.zeros((n,) + src.shape[1:], dtype=src.dtype)
    return out.index_add_(0, seg, src)
def _pad(x, pw):
    flat = tuple(v for pair in reversed(pw) for v in pair)
    return torch.nn.functional.pad(x, flat)

kernel_name = 'standalone__gqa_block_cached__near_ridge'

def setup_inputs():

    _w = (lambda a: (lambda t: t.to(torch.bfloat16) if t.is_floating_point() else t)(torch.as_tensor(a)))
    B, Sq, D = 16, 64, 512
    Hq, Hkv, Sk, Dh = 32, 8, 1024, 128
    assert Hq % Hkv == 0, (Hq, Hkv)
    return {
        "x": _w((lambda *s: torch.randn(*s, dtype=torch.bfloat16) * 0.8)(B, Sq, D)),
        "k_cache": _w((lambda *s: torch.randn(*s, dtype=torch.bfloat16) * 0.8)(B, Hkv, Sk, Dh)),
        "v_cache": _w((lambda *s: torch.randn(*s, dtype=torch.bfloat16) * 0.05)(B, Hkv, Sk, Dh)),
        "wq": _w((lambda *s: torch.randn(*s, dtype=torch.bfloat16) * 0.8)(D, Hq * Dh) * (D ** -0.5)),
        "wo": _w((lambda *s: torch.randn(*s, dtype=torch.bfloat16) * 0.05)(Hq * Dh, D) * ((Hq * Dh) ** -0.5)),
    }

def reference(x, k_cache, v_cache, wq, wo):
    B, Sq, D = x.shape
    Hq, Dh = 32, 128
    Hkv = k_cache.shape[1]
    rep = Hq // Hkv
    q = (lambda x, *d: x.permute(*d))((x @ wq).reshape(B, Sq, Hq, Dh), 0, 2, 1, 3)
    k = (lambda x, n, axis: torch.repeat_interleave(x, n, dim=axis))(k_cache, rep, axis=1)
    v = (lambda x, n, axis: torch.repeat_interleave(x, n, dim=axis))(v_cache, rep, axis=1)
    scores = torch.einsum("bhqd,bhkd->bhqk", q, k) * (Dh ** -0.5)
    p = _softmax(scores, axis=-1)
    o = torch.einsum("bhqk,bhkd->bhqd", p, v)
    return (lambda x, *d: x.permute(*d))(o, 0, 2, 1, 3).reshape(B, Sq, Hq * Dh) @ wo
```

```asm
; @launch grid=(256,1,1) block=(512,1,1) lds=163840
.amdgcn_target "amdgcn-amd-amdhsa--gfx950"
.text
.globl standalone__gqa_block_cached__near_ridge_kernel
.p2align 8
.type standalone__gqa_block_cached__near_ridge_kernel,@function
standalone__gqa_block_cached__near_ridge_kernel:
    s_cmp_ge_u32 s2, 256
    s_cbranch_scc1 L_MAIN_END
    s_load_dwordx16 s[4:19], s[0:1], 0
    s_getpc_b64 s[58:59]
L_PC:
    v_lshrrev_b32 v10, 6, v0
    s_and_b32 s55, s2, 0xf8
    v_add_lshl_u32 v11, v10, s55, 7
    v_readfirstlane_b32 s44, v10
    v_min_u32 v11, L_RED_END-L_PC, v11
    v_and_b32 v1, 63, v0
    global_load_dword v2, v11, s[58:59]
    s_and_b32 s62, s2, 7
    s_bfe_u32 s63, s2, 0x10003
    s_lshr_b32 s3, s2, 4
    s_lshl_b32 s71, s63, 3
    s_add_u32 s71, s71, s3
    s_and_b32 s71, s71, 15
    s_and_b32 s47, s44, 1
    s_mul_i32 s48, s44, 2080
    s_lshr_b32 s54, s44, 1
    s_lshl_b32 s50, s54, 10
    s_mul_i32 s55, s47, 8320
    s_add_u32 s50, s50, s55
    v_lshrrev_b32 v13, 4, v1
    v_and_b32 v12, 15, v1
    s_lshl_b32 s55, s44, 11
    v_lshl_add_u32 v10, v13, 14, s55
    s_lshl_b32 s55, s71, 6
    s_lshl_b32 s71, s71, 18
    v_lshl_add_u32 v11, v12, 4, s55
    s_movk_i32 s56, 1023
    v_and_or_b32 v195, v11, s56, v10
    v_lshrrev_b32 v14, 5, v1
    v_and_b32 v15, 31, v1
    v_lshlrev_b32 v15, 4, v15
    v_lshl_add_u32 v15, v14, 15, v15
    s_lshl_b32 s55, s54, 16
    s_lshl_b32 s57, s47, 14
    s_add_u32 s55, s55, s57
    v_add_u32 v3, s55, v15
    s_mov_b32 s23, 0x00020000
    s_mov_b32 s27, 0x00020000
    s_mov_b32 s31, 0x00020000
    s_mov_b32 s35, 0x00020000
    s_mov_b32 s39, 0x00020000
    s_mov_b32 s43, 0x00020000
    s_mov_b32 s22, 65536
    s_mov_b32 s26, 4186624
    s_lshl_b32 s55, s3, 16
    s_lshl_b32 s57, s62, 1
    s_add_u32 s57, s57, s63
    s_lshl_b32 s70, s57, 9
    s_waitcnt lgkmcnt(0)
    s_add_u32 s20, s4, s55
    s_addc_u32 s21, s5, 0
    s_add_u32 s24, s10, s70
    s_addc_u32 s25, s11, 0
    s_add_u32 m0, s48, 0
    s_nop 0
    buffer_load_dwordx4 v195, s[20:23], 0 offen offset:0 lds
    s_add_u32 m0, s48, 16
    s_nop 0
    buffer_load_dwordx4 v195, s[20:23], 0 offen offset:1024 lds
    s_add_u32 s60, s71, 0
    s_add_u32 m0, s50, 17152
    s_and_b32 s60, s60, 0x3fffff
    buffer_load_dwordx4 v3, s[24:27], s60 offen lds
    s_add_u32 s61, s71, 8192
    s_add_u32 m0, s50, 21312
    s_and_b32 s61, s61, 0x3fffff
    buffer_load_dwordx4 v3, s[24:27], s61 offen lds
    v_add_u32 v15, 256, v11
    v_and_or_b32 v196, v15, s56, v10
    v_add_u32 v15, 512, v11
    v_and_or_b32 v197, v15, s56, v10
    v_add_u32 v15, 768, v11
    v_and_or_b32 v198, v15, s56, v10
    s_lshr_b32 s45, s44, 2
    s_and_b32 s46, s54, 1
    s_mul_i32 s49, s54, 4288
    s_mul_i32 s55, s47, 2176
    s_add_u32 s49, s49, s55
    s_mov_b64 s[52:53], 0
    s_lshl_b32 s55, s57, 18
    s_add_u32 s36, s12, s55
    s_addc_u32 s37, s13, 0
    s_mov_b32 s38, 262144
    s_lshl_b32 s55, s3, 4
    s_add_u32 s55, s55, s57
    s_lshl_b32 s55, s55, 16
    s_add_u32 s40, s18, s55
    s_addc_u32 s41, s19, 0
    s_mov_b32 s42, 65536
    s_lshl_b32 s55, s3, 11
    s_add_u32 s55, s55, 0x1000000
    s_add_u32 s84, s18, s55
    s_addc_u32 s85, s19, 0
    s_mov_b32 s86, 2048
    s_mov_b32 s87, 0x00020000
    s_lshl_b32 s55, s3, 4
    s_add_u32 s88, s16, s55
    s_addc_u32 s89, s17, 0
    s_mov_b32 s90, 4
    s_mov_b32 s91, 0x00020000
    s_lshl_b32 s55, s3, 20
    s_add_u32 s92, s18, s55
    s_addc_u32 s93, s19, 0
    s_mov_b32 s94, 0x100000
    s_mov_b32 s95, 0x00020000
    s_lshl_b32 s55, s3, 16
    s_add_u32 s96, s14, s55
    s_addc_u32 s97, s15, 0
    s_mov_b32 s98, 0x10000
    s_mov_b32 s99, 0x00020000
    s_lshl_b32 s51, s44, 6
    s_lshl_b32 s55, s57, 2
    s_add_u32 s51, s51, s55
    s_mov_b32 s79, s57
    s_lshl_b32 s55, s3, 3
    s_add_u32 s55, s55, s62
    s_lshl_b32 s55, s55, 18
    s_add_u32 s28, s6, s55
    s_addc_u32 s29, s7, 0
    s_mov_b32 s30, 262144
    s_add_u32 s32, s8, s55
    s_addc_u32 s33, s9, 0
    s_mov_b32 s34, 262144
    s_lshl_b32 s70, s62, 1
    s_add_u32 s70, s70, s3
    s_and_b32 s70, s70, 15
    s_lshl_b32 s70, s70, 13
    s_lshl_b32 s55, s63, 13
    s_mov_b32 s55, 0
    s_sub_u32 s75, s70, s55
    s_add_u32 s70, s70, s55
    s_and_b32 s76, s3, 3
    s_lshl_b32 s76, s76, 16
    s_and_b32 s77, s3, 12
    s_lshl_b32 s77, s77, 6
    s_mov_b32 s74, 0x3e0293ee
    v_lshlrev_b32 v7, 4, v1
    v_and_b32 v11, 1, v13
    v_lshlrev_b32 v15, 4, v12
    v_lshl_add_u32 v4, v14, 17, v15
    v_lshl_add_u32 v4, v11, 12, v4
    s_lshl_b32 s55, s44, 9
    v_add_u32 v4, s55, v4
    v_lshl_add_u32 v5, v13, 10, v15
    s_lshl_b32 s55, s45, 17
    s_lshl_b32 s56, s46, 12
    s_add_u32 s55, s55, s56
    s_lshl_b32 s56, s47, 9
    s_add_u32 s55, s55, s56
    v_add_u32 v5, s55, v5
    v_lshl_add_u32 v6, v13, 12, v15
    s_lshl_b32 s55, s54, 14
    s_lshl_b32 s57, s47, 11
    s_add_u32 s55, s55, s57
    v_add_u32 v6, s55, v6
    v_mul_u32_u24 v208, 1040, v12
    v_lshl_add_u32 v208, v14, 4, v208
    v_lshl_add_u32 v208, v11, 8, v208
    v_add_u32 v192, s56, v208
    s_mul_i32 s55, s45, 640
    s_mul_i32 s56, s45, 384
    s_add_u32 s56, s56, 128
    v_add_u32 v211, s56, v208
    v_add_u32 v208, s55, v208
    v_and_b32 v15, 1, v1
    v_lshlrev_b32 v10, 4, v15
    v_bfe_u32 v15, v1, 1, 1
    v_lshl_add_u32 v10, v15, 3, v10
    v_lshl_add_u32 v10, v11, 5, v10
    v_bfe_u32 v12, v1, 2, 2
    v_mul_u32_u24 v220, 4160, v12
    v_lshl_add_u32 v220, v14, 10, v220
    s_lshl_b32 s55, s46, 8
    s_lshl_b32 s56, s45, 7
    s_add_u32 s55, s55, s56
    v_add3_u32 v220, v220, v10, s55
    v_mul_u32_u24 v214, 1088, v12
    v_lshl_add_u32 v214, v14, 8, v214
    s_mul_i32 s55, s45, 8704
    s_mul_i32 s56, s45, 8448
    s_add_u32 s56, s56, 128
    v_add3_u32 v217, v214, v10, s56
    v_add3_u32 v214, v214, v10, s55
    v_add_u32 v193, 51456, v192
    v_add_u32 v194, 102912, v192
    v_add_u32 v221, 51456, v220
    v_add_u32 v222, 102912, v220
    v_add_u32 v209, 51456, v208
    v_add_u32 v210, 102912, v208
    v_add_u32 v212, 51456, v211
    v_add_u32 v213, 102912, v211
    v_add_u32 v215, 51456, v214
    v_add_u32 v216, 102912, v214
    v_add_u32 v218, 51456, v217
    v_add_u32 v219, 102912, v217
    v_mul_u32_u24 v223, 1088, v12
    v_lshl_add_u32 v223, v14, 9, v223
    s_lshl_b32 s55, s54, 6
    v_add3_u32 v223, v223, v10, s55
    s_lshl_b32 s55, s44, 9
    s_add_u32 s55, s55, 154368
    v_lshlrev_b32 v13, 3, v1
    v_add_u32 v200, s55, v13
    s_xor_b32 s55, s44, 4
    s_lshl_b32 s55, s55, 9
    s_add_u32 s55, s55, 154368
    v_add_u32 v201, s55, v13
    v_mov_b32 v202, 158464
    v_mov_b32 v13, 0
    ds_write_b32 v202, v13
    s_cmp_eq_u32 s46, 0
    s_cselect_b32 s54, 0, 5
    s_cselect_b32 s55, 2, 6
    s_mul_i32 s54, s54, 17152
    s_mul_i32 s55, s55, 17152
    s_lshl_b32 s56, s47, 13
    v_add_u32 v13, s56, v7
    s_cmp_eq_u32 s45, 0
    s_cselect_b32 s56, s54, s55
    s_cselect_b32 s57, s55, s54
    v_add_u32 v203, s56, v13
    v_add_u32 v204, s57, v13
    s_cselect_b32 s54, 2, 4
    s_cselect_b32 s55, 4, 2
    s_mul_i32 s54, s54, 17152
    s_mul_i32 s55, s55, 17152
    s_and_b32 s57, s44, 3
    s_lshl_b32 s57, s57, 12
    s_add_u32 s54, s54, s57
    s_add_u32 s55, s55, s57
    v_add_u32 v10, s54, v7
    v_add_u32 v11, s55, v7
    s_lshr_b32 s55, s76, 14
    s_lshr_b32 s55, 0x65206520, s55
    s_bfe_u32 s80, s55, 0x40000
    s_mul_i32 s80, s80, 17152
    v_add_u32 v205, s80, v13
    s_bfe_u32 s80, s55, 0x40004
    s_mul_i32 s80, s80, 17152
    v_add_u32 v206, s80, v13
    s_bfe_u32 s80, s55, 0x40008
    s_mul_i32 s80, s80, 17152
    v_add_u32 v207, s80, v13
    s_bfe_u32 s80, s55, 0x4000c
    s_mul_i32 s80, s80, 17152
    s_lshl_b32 s56, s47, 13
    s_add_u32 s80, s80, s56
    v_lshlrev_b32 v15, 9, v1
    v_mov_b32 v12, 0
    buffer_store_dword v12, v15, s[84:87], s51 offen sc1
    s_add_u32 s60, s71, 262144
    s_add_u32 m0, s50, 34304
    s_and_b32 s60, s60, 0x3fffff
    buffer_load_dwordx4 v3, s[24:27], s60 offen lds
    s_add_u32 s61, s71, 270336
    s_add_u32 m0, s50, 38464
    s_and_b32 s61, s61, 0x3fffff
    buffer_load_dwordx4 v3, s[24:27], s61 offen lds
    s_cmp_ge_u32 s44, 4
    s_cbranch_scc0 L_NOPRIO
    s_setprio 1
L_NOPRIO:
    s_waitcnt vmcnt(3)
    s_barrier
    s_add_u32 m0, s48, 51456
    s_nop 0
    buffer_load_dwordx4 v196, s[20:23], 0 offen offset:0 lds
    s_add_u32 m0, s48, 51472
    s_nop 0
    buffer_load_dwordx4 v196, s[20:23], 0 offen offset:1024 lds
    s_add_u32 s61, s71, 524288
    s_add_u32 m0, s50, 68608
    s_and_b32 s61, s61, 0x3fffff
    buffer_load_dwordx4 v3, s[24:27], s61 offen lds
    s_add_u32 s60, s71, 532480
    s_add_u32 m0, s50, 72768
    s_and_b32 s60, s60, 0x3fffff
    buffer_load_dwordx4 v3, s[24:27], s60 offen lds
    ds_read_b128 v[64:67], v192 offset:0
    ds_read_b128 v[68:71], v192 offset:32
    ds_read_b64_tr_b16 v[160:161], v220 offset:17152
    ds_read_b64_tr_b16 v[162:163], v220 offset:17664
    ds_read_b64_tr_b16 v[164:165], v220 offset:17216
    ds_read_b64_tr_b16 v[166:167], v220 offset:17728
    ds_read_b64_tr_b16 v[168:169], v220 offset:19200
    ds_read_b64_tr_b16 v[170:171], v220 offset:19712
    ds_read_b64_tr_b16 v[172:173], v220 offset:19264
    ds_read_b64_tr_b16 v[174:175], v220 offset:19776
    s_waitcnt lgkmcnt(6)
    v_mfma_f32_32x32x16_bf16 v[224:239], v[160:163], v[64:67], 0
    ds_read_b128 v[72:75], v192 offset:64
    ds_read_b128 v[76:79], v192 offset:96
    s_waitcnt lgkmcnt(6)
    v_mfma_f32_32x32x16_bf16 v[240:255], v[164:167], v[64:67], 0
    ds_read_b128 v[80:83], v192 offset:128
    ds_read_b128 v[84:87], v192 offset:160
    s_add_u32 s61, s71, 786432
    s_add_u32 m0, s50, 85760
    s_and_b32 s61, s61, 0x3fffff
    buffer_load_dwordx4 v3, s[24:27], s61 offen lds
    s_waitcnt lgkmcnt(6)
    v_mfma_f32_32x32x16_bf16 v[224:239], v[168:171], v[68:71], v[224:239]
    ds_read_b128 v[88:91], v192 offset:192
    ds_read_b128 v[92:95], v192 offset:224
    s_waitcnt lgkmcnt(6)
    v_mfma_f32_32x32x16_bf16 v[240:255], v[172:175], v[68:71], v[240:255]
    s_add_u32 s60, s71, 794624
    s_add_u32 m0, s50, 89920
    s_and_b32 s60, s60, 0x3fffff
    buffer_load_dwordx4 v3, s[24:27], s60 offen lds
    s_waitcnt vmcnt(6)
    s_barrier
    ds_read_b64_tr_b16 v[176:177], v220 offset:34304
    ds_read_b64_tr_b16 v[178:179], v220 offset:34816
    ds_read_b64_tr_b16 v[180:181], v220 offset:34368
    ds_read_b64_tr_b16 v[182:183], v220 offset:34880
    ds_read_b64_tr_b16 v[184:185], v220 offset:36352
    ds_read_b64_tr_b16 v[186:187], v220 offset:36864
    ds_read_b64_tr_b16 v[188:189], v220 offset:36416
    ds_read_b64_tr_b16 v[190:191], v220 offset:36928
    s_waitcnt lgkmcnt(6)
    v_mfma_f32_32x32x16_bf16 v[224:239], v[176:179], v[72:75], v[224:239]
    s_add_u32 s61, s71, 1048576
    s_add_u32 m0, s50, 102912
    s_and_b32 s61, s61, 0x3fffff
    buffer_load_dwordx4 v3, s[24:27], s61 offen lds
    s_add_u32 s60, s71, 1056768
    s_add_u32 m0, s50, 107072
    s_and_b32 s60, s60, 0x3fffff
    buffer_load_dwordx4 v3, s[24:27], s60 offen lds
    s_waitcnt vmcnt(4)
    s_barrier
    s_add_u32 s61, s71, 1310720
    s_add_u32 m0, s50, 120064
    s_and_b32 s61, s61, 0x3fffff
    buffer_load_dwordx4 v3, s[24:27], s61 offen lds
    s_add_u32 s60, s71, 1318912
    s_add_u32 m0, s50, 124224
    s_and_b32 s60, s60, 0x3fffff
    buffer_load_dwordx4 v3, s[24:27], s60 offen lds
    ds_read_b64_tr_b16 v[160:161], v221 offset:17152
    ds_read_b64_tr_b16 v[162:163], v221 offset:17664
    s_waitcnt lgkmcnt(6)
    v_mfma_f32_32x32x16_bf16 v[240:255], v[180:183], v[72:75], v[240:255]
    ds_read_b64_tr_b16 v[164:165], v221 offset:17216
    ds_read_b64_tr_b16 v[166:167], v221 offset:17728
    s_waitcnt lgkmcnt(6)
    v_mfma_f32_32x32x16_bf16 v[224:239], v[184:187], v[76:79], v[224:239]
    s_add_u32 s61, s71, 1572864
    s_add_u32 m0, s50, 137216
    s_and_b32 s61, s61, 0x3fffff
    buffer_load_dwordx4 v3, s[24:27], s61 offen lds
    ds_read_b64_tr_b16 v[168:169], v221 offset:19200
    ds_read_b64_tr_b16 v[170:171], v221 offset:19712
    s_waitcnt lgkmcnt(6)
    v_mfma_f32_32x32x16_bf16 v[240:255], v[188:191], v[76:79], v[240:255]
    s_add_u32 s60, s71, 1581056
    s_add_u32 m0, s50, 141376
    s_and_b32 s60, s60, 0x3fffff
    buffer_load_dwordx4 v3, s[24:27], s60 offen lds
    s_waitcnt vmcnt(6)
    s_barrier
    ds_read_b64_tr_b16 v[172:173], v221 offset:19264
    ds_read_b64_tr_b16 v[174:175], v221 offset:19776
    s_waitcnt lgkmcnt(6)
    v_mfma_f32_32x32x16_bf16 v[224:239], v[160:163], v[80:83], v[224:239]
    ds_read_b128 v[96:99], v193 offset:0
    ds_read_b128 v[100:103], v193 offset:32
    ds_read_b64_tr_b16 v[176:177], v221 offset:34304
    ds_read_b64_tr_b16 v[178:179], v221 offset:34816
    s_waitcnt lgkmcnt(8)
    v_mfma_f32_32x32x16_bf16 v[240:255], v[164:167], v[80:83], v[240:255]
    ds_read_b128 v[104:107], v193 offset:64
    ds_read_b128 v[108:111], v193 offset:96
    s_add_u32 m0, s48, 17152
    s_nop 0
    buffer_load_dwordx4 v197, s[20:23], 0 offen offset:0 lds
    ds_read_b64_tr_b16 v[180:181], v221 offset:34368
    ds_read_b64_tr_b16 v[182:183], v221 offset:34880
    s_waitcnt lgkmcnt(10)
    v_mfma_f32_32x32x16_bf16 v[224:239], v[168:171], v[84:87], v[224:239]
    ds_read_b128 v[112:115], v193 offset:128
    ds_read_b128 v[116:119], v193 offset:160
    ds_read_b64_tr_b16 v[184:185], v221 offset:36352
    ds_read_b64_tr_b16 v[186:187], v221 offset:36864
    s_waitcnt lgkmcnt(12)
    v_mfma_f32_32x32x16_bf16 v[240:255], v[172:175], v[84:87], v[240:255]
    ds_read_b128 v[120:123], v193 offset:192
    ds_read_b128 v[124:127], v193 offset:224
    s_add_u32 m0, s48, 17168
    s_nop 0
    buffer_load_dwordx4 v197, s[20:23], 0 offen offset:1024 lds
    s_waitcnt vmcnt(6)
    s_barrier
    ds_read_b64_tr_b16 v[188:189], v221 offset:36416
    s_waitcnt lgkmcnt(14)
    ds_read_b64_tr_b16 v[190:191], v221 offset:36928
    s_waitcnt lgkmcnt(12)
    v_mfma_f32_32x32x16_bf16 v[224:239], v[176:179], v[88:91], v[224:239]
    ds_read_b64_tr_b16 v[160:161], v222 offset:0
    ds_read_b64_tr_b16 v[162:163], v222 offset:512
    s_waitcnt lgkmcnt(10)
    v_mfma_f32_32x32x16_bf16 v[240:255], v[180:183], v[88:91], v[240:255]
    s_add_u32 s60, s71, 1835008
    s_add_u32 m0, s50, 0
    s_and_b32 s60, s60, 0x3fffff
    buffer_load_dwordx4 v3, s[24:27], s60 offen lds
    ds_read_b64_tr_b16 v[164:165], v222 offset:64
    ds_read_b64_tr_b16 v[166:167], v222 offset:576
    s_waitcnt lgkmcnt(8)
    v_mfma_f32_32x32x16_bf16 v[224:239], v[184:187], v[92:95], v[224:239]
    ds_read_b64_tr_b16 v[168:169], v222 offset:2048
    ds_read_b64_tr_b16 v[170:171], v222 offset:2560
    s_waitcnt lgkmcnt(6)
    v_mfma_f32_32x32x16_bf16 v[240:255], v[188:191], v[92:95], v[240:255]
    s_add_u32 s61, s71, 1843200
    s_add_u32 m0, s50, 4160
    s_and_b32 s61, s61, 0x3fffff
    buffer_load_dwordx4 v3, s[24:27], s61 offen lds
    s_waitcnt vmcnt(6)
    s_barrier
    ds_read_b64_tr_b16 v[172:173], v222 offset:2112
    ds_read_b64_tr_b16 v[174:175], v222 offset:2624
    s_waitcnt lgkmcnt(6)
    v_mfma_f32_32x32x16_bf16 v[224:239], v[160:163], v[96:99], v[224:239]
    ds_read_b64_tr_b16 v[176:177], v222 offset:17152
    ds_read_b64_tr_b16 v[178:179], v222 offset:17664
    s_waitcnt lgkmcnt(6)
    v_mfma_f32_32x32x16_bf16 v[240:255], v[164:167], v[96:99], v[240:255]
    s_add_u32 s60, s71, 2097152
    s_add_u32 m0, s50, 34304
    s_and_b32 s60, s60, 0x3fffff
    buffer_load_dwordx4 v3, s[24:27], s60 offen lds
    ds_read_b64_tr_b16 v[180:181], v222 offset:17216
    ds_read_b64_tr_b16 v[182:183], v222 offset:17728
    s_waitcnt lgkmcnt(6)
    v_mfma_f32_32x32x16_bf16 v[224:239], v[168:171], v[100:103], v[224:239]
    ds_read_b64_tr_b16 v[184:185], v222 offset:19200
    ds_read_b64_tr_b16 v[186:187], v222 offset:19712
    s_waitcnt lgkmcnt(6)
    v_mfma_f32_32x32x16_bf16 v[240:255], v[172:175], v[100:103], v[240:255]
    s_add_u32 s61, s71, 2105344
    s_add_u32 m0, s50, 38464
    s_and_b32 s61, s61, 0x3fffff
    buffer_load_dwordx4 v3, s[24:27], s61 offen lds
    s_waitcnt vmcnt(6)
    s_barrier
    ds_read_b64_tr_b16 v[188:189], v222 offset:19264
    ds_read_b64_tr_b16 v[190:191], v222 offset:19776
    s_waitcnt lgkmcnt(6)
    v_mfma_f32_32x32x16_bf16 v[224:239], v[176:179], v[104:107], v[224:239]
    ds_read_b64_tr_b16 v[160:161], v222 offset:34304
    ds_read_b64_tr_b16 v[162:163], v222 offset:34816
    s_waitcnt lgkmcnt(6)
    v_mfma_f32_32x32x16_bf16 v[240:255], v[180:183], v[104:107], v[240:255]
    s_add_u32 s60, s71, 2359296
    s_add_u32 m0, s50, 68608
    s_and_b32 s60, s60, 0x3fffff
    buffer_load_dwordx4 v3, s[24:27], s60 offen lds
    ds_read_b64_tr_b16 v[164:165], v222 offset:34368
    ds_read_b64_tr_b16 v[166:167], v222 offset:34880
    s_waitcnt lgkmcnt(6)
    v_mfma_f32_32x32x16_bf16 v[224:239], v[184:187], v[108:111], v[224:239]
    ds_read_b64_tr_b16 v[168:169], v222 offset:36352
    ds_read_b64_tr_b16 v[170:171], v222 offset:36864
    s_waitcnt lgkmcnt(6)
    v_mfma_f32_32x32x16_bf16 v[240:255], v[188:191], v[108:111], v[240:255]
    s_add_u32 s61, s71, 2367488
    s_add_u32 m0, s50, 72768
    s_and_b32 s61, s61, 0x3fffff
    buffer_load_dwordx4 v3, s[24:27], s61 offen lds
    s_waitcnt vmcnt(4)
    s_barrier
    s_add_u32 s60, s71, 2621440
    s_add_u32 m0, s50, 51456
    s_and_b32 s60, s60, 0x3fffff
    buffer_load_dwordx4 v3, s[24:27], s60 offen lds
    s_add_u32 s61, s71, 2629632
    s_add_u32 m0, s50, 55616
    s_and_b32 s61, s61, 0x3fffff
    buffer_load_dwordx4 v3, s[24:27], s61 offen lds
    ds_read_b64_tr_b16 v[172:173], v222 offset:36416
    ds_read_b64_tr_b16 v[174:175], v222 offset:36928
    s_waitcnt lgkmcnt(6)
    v_mfma_f32_32x32x16_bf16 v[224:239], v[160:163], v[112:115], v[224:239]
    ds_read_b128 v[128:131], v192 offset:17152
    ds_read_b128 v[132:135], v192 offset:17184
    ds_read_b64_tr_b16 v[176:177], v220 offset:0
    ds_read_b64_tr_b16 v[178:179], v220 offset:512
    s_waitcnt lgkmcnt(8)
    v_mfma_f32_32x32x16_bf16 v[240:255], v[164:167], v[112:115], v[240:255]
    ds_read_b128 v[136:139], v192 offset:17216
    ds_read_b128 v[140:143], v192 offset:17248
    s_add_u32 m0, s48, 85760
    s_nop 0
    buffer_load_dwordx4 v198, s[20:23], 0 offen offset:0 lds
    ds_read_b64_tr_b16 v[180:181], v220 offset:64
    ds_read_b64_tr_b16 v[182:183], v220 offset:576
    s_waitcnt lgkmcnt(10)
    v_mfma_f32_32x32x16_bf16 v[224:239], v[168:171], v[116:119], v[224:239]
    ds_read_b128 v[144:147], v192 offset:17280
    ds_read_b128 v[148:151], v192 offset:17312
    ds_read_b64_tr_b16 v[184:185], v220 offset:2048
    ds_read_b64_tr_b16 v[186:187], v220 offset:2560
    s_waitcnt lgkmcnt(12)
    v_mfma_f32_32x32x16_bf16 v[240:255], v[172:175], v[116:119], v[240:255]
    ds_read_b128 v[152:155], v192 offset:17344
    ds_read_b128 v[156:159], v192 offset:17376
    s_add_u32 m0, s48, 85776
    s_nop 0
    buffer_load_dwordx4 v198, s[20:23], 0 offen offset:1024 lds
    s_waitcnt vmcnt(6)
    s_barrier
    ds_read_b64_tr_b16 v[188:189], v220 offset:2112
    s_waitcnt lgkmcnt(14)
    ds_read_b64_tr_b16 v[190:191], v220 offset:2624
    s_waitcnt lgkmcnt(12)
    v_mfma_f32_32x32x16_bf16 v[224:239], v[176:179], v[120:123], v[224:239]
    ds_read_b64_tr_b16 v[160:161], v220 offset:34304
    ds_read_b64_tr_b16 v[162:163], v220 offset:34816
    s_waitcnt lgkmcnt(10)
    v_mfma_f32_32x32x16_bf16 v[240:255], v[180:183], v[120:123], v[240:255]
    s_add_u32 s61, s71, 2883584
    s_add_u32 m0, s50, 102912
    s_and_b32 s61, s61, 0x3fffff
    buffer_load_dwordx4 v3, s[24:27], s61 offen lds
    ds_read_b64_tr_b16 v[164:165], v220 offset:34368
    ds_read_b64_tr_b16 v[166:167], v220 offset:34880
    s_waitcnt lgkmcnt(8)
    v_mfma_f32_32x32x16_bf16 v[224:239], v[184:187], v[124:127], v[224:239]
    ds_read_b64_tr_b16 v[168:169], v220 offset:36352
    ds_read_b64_tr_b16 v[170:171], v220 offset:36864
    s_waitcnt lgkmcnt(6)
    v_mfma_f32_32x32x16_bf16 v[240:255], v[188:191], v[124:127], v[240:255]
    s_add_u32 s60, s71, 2891776
    s_add_u32 m0, s50, 107072
    s_and_b32 s60, s60, 0x3fffff
    buffer_load_dwordx4 v3, s[24:27], s60 offen lds
    s_waitcnt vmcnt(6)
    s_barrier
    ds_read_b64_tr_b16 v[172:173], v220 offset:36416
    ds_read_b64_tr_b16 v[174:175], v220 offset:36928
    s_waitcnt lgkmcnt(6)
    v_mfma_f32_32x32x16_bf16 v[224:239], v[160:163], v[128:131], v[224:239]
    ds_read_b64_tr_b16 v[176:177], v221 offset:17152
    ds_read_b64_tr_b16 v[178:179], v221 offset:17664
    s_waitcnt lgkmcnt(6)
    v_mfma_f32_32x32x16_bf16 v[240:255], v[164:167], v[128:131], v[240:255]
    s_add_u32 s61, s71, 3145728
    s_add_u32 m0, s50, 120064
    s_and_b32 s61, s61, 0x3fffff
    buffer_load_dwordx4 v3, s[24:27], s61 offen lds
    ds_read_b64_tr_b16 v[180:181], v221 offset:17216
    ds_read_b64_tr_b16 v[182:183], v221 offset:17728
    s_waitcnt lgkmcnt(6)
    v_mfma_f32_32x32x16_bf16 v[224:239], v[168:171], v[132:135], v[224:239]
    ds_read_b64_tr_b16 v[184:185], v221 offset:19200
    ds_read_b64_tr_b16 v[186:187], v221 offset:19712
    s_waitcnt lgkmcnt(6)
    v_mfma_f32_32x32x16_bf16 v[240:255], v[172:175], v[132:135], v[240:255]
    s_add_u32 s60, s71, 3153920
    s_add_u32 m0, s50, 124224
    s_and_b32 s60, s60, 0x3fffff
    buffer_load_dwordx4 v3, s[24:27], s60 offen lds
    s_waitcnt vmcnt(6)
    s_barrier
    ds_read_b64_tr_b16 v[188:189], v221 offset:19264
    ds_read_b64_tr_b16 v[190:191], v221 offset:19776
    s_waitcnt lgkmcnt(6)
    v_mfma_f32_32x32x16_bf16 v[224:239], v[176:179], v[136:139], v[224:239]
    ds_read_b64_tr_b16 v[160:161], v221 offset:0
    ds_read_b64_tr_b16 v[162:163], v221 offset:512
    s_waitcnt lgkmcnt(6)
    v_mfma_f32_32x32x16_bf16 v[240:255], v[180:183], v[136:139], v[240:255]
    s_add_u32 s61, s71, 3407872
    s_add_u32 m0, s50, 137216
    s_and_b32 s61, s61, 0x3fffff
    buffer_load_dwordx4 v3, s[24:27], s61 offen lds
    ds_read_b64_tr_b16 v[164:165], v221 offset:64
    ds_read_b64_tr_b16 v[166:167], v221 offset:576
    s_waitcnt lgkmcnt(6)
    v_mfma_f32_32x32x16_bf16 v[224:239], v[184:187], v[140:143], v[224:239]
    ds_read_b64_tr_b16 v[168:169], v221 offset:2048
    ds_read_b64_tr_b16 v[170:171], v221 offset:2560
    s_waitcnt lgkmcnt(6)
    v_mfma_f32_32x32x16_bf16 v[240:255], v[188:191], v[140:143], v[240:255]
    s_add_u32 s60, s71, 3416064
    s_add_u32 m0, s50, 141376
    s_and_b32 s60, s60, 0x3fffff
    buffer_load_dwordx4 v3, s[24:27], s60 offen lds
    s_waitcnt vmcnt(4)
    s_barrier
    s_add_u32 s61, s71, 3670016
    s_add_u32 m0, s50, 17152
    s_and_b32 s61, s61, 0x3fffff
    buffer_load_dwordx4 v3, s[24:27], s61 offen lds
    s_add_u32 s60, s71, 3678208
    s_add_u32 m0, s50, 21312
    s_and_b32 s60, s60, 0x3fffff
    buffer_load_dwordx4 v3, s[24:27], s60 offen lds
    ds_read_b64_tr_b16 v[172:173], v221 offset:2112
    ds_read_b64_tr_b16 v[174:175], v221 offset:2624
    s_waitcnt lgkmcnt(6)
    v_mfma_f32_32x32x16_bf16 v[224:239], v[160:163], v[144:147], v[224:239]
    ds_read_b128 v[48:51], v193 offset:34304
    ds_read_b128 v[52:55], v193 offset:34336
    ds_read_b64_tr_b16 v[176:177], v222 offset:0
    ds_read_b64_tr_b16 v[178:179], v222 offset:512
    s_waitcnt lgkmcnt(8)
    v_mfma_f32_32x32x16_bf16 v[240:255], v[164:167], v[144:147], v[240:255]
    ds_read_b128 v[56:59], v193 offset:34368
    ds_read_b128 v[60:63], v193 offset:34400
    s_add_u32 s61, s71, 3932160
    s_add_u32 m0, s50, 0
    s_and_b32 s61, s61, 0x3fffff
    buffer_load_dwordx4 v3, s[24:27], s61 offen lds
    ds_read_b64_tr_b16 v[180:181], v222 offset:64
    ds_read_b64_tr_b16 v[182:183], v222 offset:576
    s_waitcnt lgkmcnt(10)
    v_mfma_f32_32x32x16_bf16 v[224:239], v[168:171], v[148:151], v[224:239]
    ds_read_b128 v[32:35], v193 offset:34432
    ds_read_b128 v[36:39], v193 offset:34464
    ds_read_b64_tr_b16 v[184:185], v222 offset:2048
    ds_read_b64_tr_b16 v[186:187], v222 offset:2560
    s_waitcnt lgkmcnt(12)
    v_mfma_f32_32x32x16_bf16 v[240:255], v[172:175], v[148:151], v[240:255]
    ds_read_b128 v[40:43], v193 offset:34496
    ds_read_b128 v[44:47], v193 offset:34528
    s_add_u32 s60, s71, 3940352
    s_add_u32 m0, s50, 4160
    s_and_b32 s60, s60, 0x3fffff
    buffer_load_dwordx4 v3, s[24:27], s60 offen lds
    s_waitcnt vmcnt(6)
    s_barrier
    ds_read_b64_tr_b16 v[188:189], v222 offset:2112
    s_waitcnt lgkmcnt(14)
    ds_read_b64_tr_b16 v[190:191], v222 offset:2624
    s_waitcnt lgkmcnt(12)
    v_mfma_f32_32x32x16_bf16 v[224:239], v[176:179], v[152:155], v[224:239]
    ds_read_b64_tr_b16 v[160:161], v222 offset:17152
    ds_read_b64_tr_b16 v[162:163], v222 offset:17664
    s_waitcnt lgkmcnt(10)
    v_mfma_f32_32x32x16_bf16 v[240:255], v[180:183], v[152:155], v[240:255]
    s_add_u32 s61, s70, 0
    s_add_u32 m0, s48, 51456
    s_and_b32 s61, s61, 0x1ffff
    buffer_load_dwordx4 v4, s[28:31], s61 offen offset:0 nt lds
    ds_read_b64_tr_b16 v[164:165], v222 offset:17216
    ds_read_b64_tr_b16 v[166:167], v222 offset:17728
    s_waitcnt lgkmcnt(8)
    v_mfma_f32_32x32x16_bf16 v[224:239], v[184:187], v[156:159], v[224:239]
    ds_read_b64_tr_b16 v[168:169], v222 offset:19200
    ds_read_b64_tr_b16 v[170:171], v222 offset:19712
    s_waitcnt lgkmcnt(6)
    v_mfma_f32_32x32x16_bf16 v[240:255], v[188:191], v[156:159], v[240:255]
    s_add_u32 m0, s48, 52240
    s_nop 0
    buffer_load_dwordx4 v4, s[28:31], s61 offen offset:256 nt lds
    s_waitcnt vmcnt(6)
    s_barrier
    ds_read_b64_tr_b16 v[172:173], v222 offset:19264
    ds_read_b64_tr_b16 v[174:175], v222 offset:19776
    s_waitcnt lgkmcnt(6)
    v_mfma_f32_32x32x16_bf16 v[224:239], v[160:163], v[48:51], v[224:239]
    ds_read_b64_tr_b16 v[176:177], v222 offset:34304
    ds_read_b64_tr_b16 v[178:179], v222 offset:34816
    s_waitcnt lgkmcnt(6)
    v_mfma_f32_32x32x16_bf16 v[240:255], v[164:167], v[48:51], v[240:255]
    s_add_u32 s60, s75, 8192
    s_add_u32 m0, s48, 85760
    s_and_b32 s60, s60, 0x1ffff
    buffer_load_dwordx4 v4, s[28:31], s60 offen offset:0 nt lds
    ds_read_b64_tr_b16 v[180:181], v222 offset:34368
    ds_read_b64_tr_b16 v[182:183], v222 offset:34880
    s_waitcnt lgkmcnt(6)
    v_mfma_f32_32x32x16_bf16 v[224:239], v[168:171], v[52:55], v[224:239]
    ds_read_b64_tr_b16 v[184:185], v222 offset:36352
    ds_read_b64_tr_b16 v[186:187], v222 offset:36864
    s_waitcnt lgkmcnt(6)
    v_mfma_f32_32x32x16_bf16 v[240:255], v[172:175], v[52:55], v[240:255]
    s_add_u32 m0, s48, 86544
    s_nop 0
    buffer_load_dwordx4 v4, s[28:31], s60 offen offset:256 nt lds
    s_waitcnt vmcnt(6)
    s_barrier
    ds_read_b64_tr_b16 v[188:189], v222 offset:36416
    ds_read_b64_tr_b16 v[190:191], v222 offset:36928
    s_waitcnt lgkmcnt(6)
    v_mfma_f32_32x32x16_bf16 v[224:239], v[176:179], v[56:59], v[224:239]
    ds_read_b64_tr_b16 v[160:161], v220 offset:17152
    ds_read_b64_tr_b16 v[162:163], v220 offset:17664
    s_waitcnt lgkmcnt(6)
    v_mfma_f32_32x32x16_bf16 v[240:255], v[180:183], v[56:59], v[240:255]
    s_add_u32 s61, s70, 0
    s_add_u32 m0, s49, 102912
    s_and_b32 s61, s61, 0x1ffff
    buffer_load_dwordx4 v5, s[32:35], s61 offen offset:0 nt lds
    s_add_u32 m0, s49, 103744
    s_nop 0
    buffer_load_dwordx4 v5, s[32:35], s61 offen offset:256 nt lds
    s_waitcnt vmcnt(6)
    s_barrier
    ds_read_b64_tr_b16 v[164:165], v220 offset:19200
    ds_read_b64_tr_b16 v[166:167], v220 offset:19712
    s_waitcnt lgkmcnt(6)
    v_mfma_f32_32x32x16_bf16 v[224:239], v[184:187], v[60:63], v[224:239]
    ds_read_b64_tr_b16 v[168:169], v220 offset:0
    ds_read_b64_tr_b16 v[170:171], v220 offset:512
    s_waitcnt lgkmcnt(6)
    v_mfma_f32_32x32x16_bf16 v[240:255], v[188:191], v[60:63], v[240:255]
    s_add_u32 s60, s70, 16384
    s_add_u32 m0, s48, 120064
    s_and_b32 s60, s60, 0x1ffff
    buffer_load_dwordx4 v4, s[28:31], s60 offen offset:0 nt lds
    ds_read_b64_tr_b16 v[172:173], v220 offset:2048
    ds_read_b64_tr_b16 v[174:175], v220 offset:2560
    s_waitcnt lgkmcnt(6)
    v_mfma_f32_32x32x16_bf16 v[224:239], v[160:163], v[32:35], v[224:239]
    ds_read_b64_tr_b16 v[176:177], v220 offset:17216
    ds_read_b64_tr_b16 v[178:179], v220 offset:17728
    s_waitcnt lgkmcnt(6)
    v_mfma_f32_32x32x16_bf16 v[224:239], v[164:167], v[36:39], v[224:239]
    s_add_u32 m0, s48, 120848
    s_nop 0
    buffer_load_dwordx4 v4, s[28:31], s60 offen offset:256 nt lds
    ds_read_b64_tr_b16 v[180:181], v220 offset:19264
    ds_read_b64_tr_b16 v[182:183], v220 offset:19776
    s_waitcnt lgkmcnt(6)
    v_mfma_f32_32x32x16_bf16 v[224:239], v[168:171], v[40:43], v[224:239]
    ds_read_b64_tr_b16 v[184:185], v220 offset:64
    ds_read_b64_tr_b16 v[186:187], v220 offset:576
    s_waitcnt lgkmcnt(6)
    v_mfma_f32_32x32x16_bf16 v[224:239], v[172:175], v[44:47], v[224:239]
    ds_read_b64_tr_b16 v[188:189], v220 offset:2112
    ds_read_b64_tr_b16 v[190:191], v220 offset:2624
    s_waitcnt lgkmcnt(6)
    v_mfma_f32_32x32x16_bf16 v[240:255], v[176:179], v[32:35], v[240:255]
    s_waitcnt lgkmcnt(4)
    v_mfma_f32_32x32x16_bf16 v[240:255], v[180:183], v[36:39], v[240:255]
    s_nop 5
    v_mul_f32 v224, s74, v224
    v_mul_f32 v225, s74, v225
    v_mul_f32 v226, s74, v226
    v_mul_f32 v227, s74, v227
    v_mul_f32 v228, s74, v228
    v_mul_f32 v229, s74, v229
    v_mul_f32 v230, s74, v230
    v_mul_f32 v231, s74, v231
    v_cvt_pk_bf16_f32 v16, v224, v225
    v_cvt_pk_bf16_f32 v17, v226, v227
    v_cvt_pk_bf16_f32 v18, v228, v229
    v_cvt_pk_bf16_f32 v19, v230, v231
    ds_write_b128 v10, v[16:19] offset:0
    s_waitcnt vmcnt(4)
    s_barrier
    s_add_u32 s61, s75, 8192
    s_add_u32 m0, s49, 137216
    s_and_b32 s61, s61, 0x1ffff
    buffer_load_dwordx4 v5, s[32:35], s61 offen offset:0 nt lds
    s_add_u32 m0, s49, 138048
    s_nop 0
    buffer_load_dwordx4 v5, s[32:35], s61 offen offset:256 nt lds
    ds_read_b128 v[160:163], v209 offset:0
    ds_read_b128 v[164:167], v209 offset:32
    ds_read_b128 v[168:171], v209 offset:34304
    ds_read_b128 v[172:175], v209 offset:34336
    ds_read_b128 v[176:179], v209 offset:64
    s_waitcnt lgkmcnt(8)
    v_mfma_f32_32x32x16_bf16 v[240:255], v[184:187], v[40:43], v[240:255]
    v_mul_f32 v232, s74, v232
    v_mul_f32 v233, s74, v233
    v_mul_f32 v234, s74, v234
    v_mul_f32 v235, s74, v235
    v_mul_f32 v236, s74, v236
    v_mul_f32 v237, s74, v237
    v_mul_f32 v238, s74, v238
    v_mul_f32 v239, s74, v239
    v_cvt_pk_bf16_f32 v20, v232, v233
    v_cvt_pk_bf16_f32 v21, v234, v235
    v_cvt_pk_bf16_f32 v22, v236, v237
    v_cvt_pk_bf16_f32 v23, v238, v239
    ds_write_b128 v10, v[20:23] offset:1024
    ds_read_b128 v[180:183], v209 offset:96
    s_waitcnt lgkmcnt(8)
    v_mfma_f32_32x32x16_bf16 v[240:255], v[188:191], v[44:47], v[240:255]
    s_add_u32 s60, s75, 24576
    s_add_u32 m0, s48, 17152
    s_and_b32 s60, s60, 0x1ffff
    buffer_load_dwordx4 v4, s[28:31], s60 offen offset:0 nt lds
    ds_read_b128 v[184:187], v209 offset:34368
    s_waitcnt lgkmcnt(6)
    v_mfma_f32_32x32x16_bf16 v[128:143], v[160:163], v[16:19], 0
    ds_read_b128 v[188:191], v209 offset:34400
    v_mfma_f32_32x32x16_bf16 v[128:143], v[164:167], v[20:23], v[128:143]
    s_nop 2
    v_mul_f32 v240, s74, v240
    v_mul_f32 v241, s74, v241
    v_mul_f32 v242, s74, v242
    v_mul_f32 v243, s74, v243
    v_mul_f32 v244, s74, v244
    v_mul_f32 v245, s74, v245
    v_mul_f32 v246, s74, v246
    v_mul_f32 v247, s74, v247
    v_cvt_pk_bf16_f32 v24, v240, v241
    v_cvt_pk_bf16_f32 v25, v242, v243
    v_cvt_pk_bf16_f32 v26, v244, v245
    v_cvt_pk_bf16_f32 v27, v246, v247
    ds_write_b128 v10, v[24:27] offset:2048
    ds_read_b128 v[160:163], v212 offset:0
    s_waitcnt lgkmcnt(7)
    v_mfma_f32_32x32x16_bf16 v[144:159], v[168:171], v[16:19], 0
    v_mul_f32 v248, s74, v248
    v_mul_f32 v249, s74, v249
    v_mul_f32 v250, s74, v250
    v_mul_f32 v251, s74, v251
    v_mul_f32 v252, s74, v252
    v_mul_f32 v253, s74, v253
    v_mul_f32 v254, s74, v254
    v_mul_f32 v255, s74, v255
    v_cvt_pk_bf16_f32 v28, v248, v249
    v_cvt_pk_bf16_f32 v29, v250, v251
    v_cvt_pk_bf16_f32 v30, v252, v253
    v_cvt_pk_bf16_f32 v31, v254, v255
    ds_write_b128 v10, v[28:31] offset:3072
    ds_read_b128 v[164:167], v212 offset:32
    v_mfma_f32_32x32x16_bf16 v[144:159], v[172:175], v[20:23], v[144:159]
    s_add_u32 m0, s48, 17936
    s_nop 0
    buffer_load_dwordx4 v4, s[28:31], s60 offen offset:256 nt lds
    ds_read_b128 v[168:171], v212 offset:64
    s_waitcnt lgkmcnt(7)
    v_mfma_f32_32x32x16_bf16 v[128:143], v[176:179], v[24:27], v[128:143]
    ds_read_b128 v[172:175], v212 offset:96
    v_mfma_f32_32x32x16_bf16 v[128:143], v[180:183], v[28:31], v[128:143]
    s_waitcnt lgkmcnt(0)
    s_barrier
    ds_read_b128 v[32:35], v11 offset:0
    ds_read_b128 v[36:39], v11 offset:1024
    ds_read_b128 v[40:43], v11 offset:2048
    ds_read_b128 v[44:47], v11 offset:3072
    ds_read_b128 v[176:179], v212 offset:34304
    v_mfma_f32_32x32x16_bf16 v[144:159], v[184:187], v[24:27], v[144:159]
    v_mov_b32 v220, v223
    v_add_u32 v221, 51456, v223
    v_add_u32 v222, 102912, v223
    v_add_u32 v223, s80, v7
    ds_read_b128 v[180:183], v212 offset:34336
    v_mfma_f32_32x32x16_bf16 v[144:159], v[188:191], v[28:31], v[144:159]
    s_lshl_b32 s55, s44, 8
    v_lshl_add_u32 v12, v1, 2, s55
    v_mov_b32 v13, 1
    buffer_atomic_add v13, v12, s[88:91], 0 offen sc1
    s_add_u32 s61, s70, 16384
    s_add_u32 m0, s49, 0
    s_and_b32 s61, s61, 0x1ffff
    buffer_load_dwordx4 v5, s[32:35], s61 offen offset:0 nt lds
    s_add_u32 m0, s49, 832
    s_nop 0
    buffer_load_dwordx4 v5, s[32:35], s61 offen offset:256 nt lds
L_ATTN2:
    ds_read_b128 v[184:187], v212 offset:34368
    s_waitcnt lgkmcnt(6)
    v_mfma_f32_32x32x16_bf16 v[128:143], v[160:163], v[32:35], v[128:143]
    ds_read_b128 v[188:191], v212 offset:34400
    s_waitcnt lgkmcnt(6)
    v_mfma_f32_32x32x16_bf16 v[128:143], v[164:167], v[36:39], v[128:143]
    s_waitcnt vmcnt(9)
    s_barrier
    ds_read_b64_tr_b16 v[160:161], v216 offset:0
    ds_read_b64_tr_b16 v[162:163], v216 offset:512
    s_waitcnt lgkmcnt(7)
    v_mfma_f32_32x32x16_bf16 v[128:143], v[168:171], v[40:43], v[128:143]
    ds_read_b64_tr_b16 v[164:165], v216 offset:64
    ds_read_b64_tr_b16 v[166:167], v216 offset:576
    s_waitcnt lgkmcnt(8)
    v_mfma_f32_32x32x16_bf16 v[128:143], v[172:175], v[44:47], v[128:143]
    s_add_u32 s60, s70, 32768
    s_add_u32 m0, s48, 51456
    s_and_b32 s60, s60, 0x1ffff
    buffer_load_dwordx4 v4, s[28:31], s60 offen offset:0 nt lds
    ds_read_b64_tr_b16 v[168:169], v219 offset:0
    ds_read_b64_tr_b16 v[170:171], v219 offset:512
    s_waitcnt lgkmcnt(8)
    v_mfma_f32_32x32x16_bf16 v[144:159], v[176:179], v[32:35], v[144:159]
    ds_read_b64_tr_b16 v[172:173], v219 offset:64
    ds_read_b64_tr_b16 v[174:175], v219 offset:576
    v_mfma_f32_32x32x16_bf16 v[144:159], v[180:183], v[36:39], v[144:159]
    s_nop 0
    v_max3_f32 v10, v128, v129, v130
    v_max3_f32 v11, v131, v132, v133
    v_max3_f32 v10, v10, v134, v135
    v_max3_f32 v11, v11, v136, v137
    v_max3_f32 v10, v10, v138, v139
    v_max3_f32 v11, v11, v140, v141
    v_max3_f32 v10, v10, v142, v143
    v_max_f32 v10, v10, v11
    v_mov_b32 v11, v10
    s_nop 1
    v_permlane32_swap_b32 v10, v11
    v_max_f32 v10, v10, v11
    v_cndmask_b32 v10, v10, v0, s[52:53]
    v_sub_f32 v48, 0, v10
    ds_read_b64_tr_b16 v[176:177], v216 offset:4288
    ds_read_b64_tr_b16 v[178:179], v216 offset:4800
    s_waitcnt lgkmcnt(10)
    v_mfma_f32_32x32x16_bf16 v[144:159], v[184:187], v[40:43], v[144:159]
    v_add_f32 v128, v48, v128
    v_add_f32 v129, v48, v129
    v_exp_f32 v128, v128
    v_exp_f32 v129, v129
    v_add_f32 v130, v48, v130
    v_add_f32 v131, v48, v131
    v_exp_f32 v130, v130
    v_exp_f32 v131, v131
    v_mov_b32 v8, v128
    v_mov_b32 v9, v129
    v_cvt_pk_bf16_f32 v128, v128, v129
    v_add_f32 v8, v8, v130
    v_add_f32 v9, v9, v131
    v_cvt_pk_bf16_f32 v129, v130, v131
    ds_read_b64_tr_b16 v[180:181], v216 offset:4352
    ds_read_b64_tr_b16 v[182:183], v216 offset:4864
    v_mfma_f32_32x32x16_bf16 v[144:159], v[188:191], v[44:47], v[144:159]
    v_add_f32 v132, v48, v132
    v_add_f32 v133, v48, v133
    v_exp_f32 v132, v132
    v_exp_f32 v133, v133
    v_add_f32 v134, v48, v134
    v_add_f32 v135, v48, v135
    v_exp_f32 v134, v134
    v_exp_f32 v135, v135
    v_add_f32 v8, v8, v132
    v_add_f32 v9, v9, v133
    v_cvt_pk_bf16_f32 v130, v132, v133
    v_add_f32 v8, v8, v134
    v_add_f32 v9, v9, v135
    v_cvt_pk_bf16_f32 v131, v134, v135
    s_add_u32 m0, s48, 52240
    s_nop 0
    buffer_load_dwordx4 v4, s[28:31], s60 offen offset:256 nt lds
    ds_read_b64_tr_b16 v[184:185], v219 offset:4288
    ds_read_b64_tr_b16 v[186:187], v219 offset:4800
    s_waitcnt lgkmcnt(10)
    v_mfma_f32_32x32x16_bf16 v[64:79], v[160:163], v[128:131], 0
    v_add_f32 v136, v48, v136
    v_add_f32 v137, v48, v137
    v_exp_f32 v136, v136
    v_exp_f32 v137, v137
    v_add_f32 v8, v8, v136
    v_add_f32 v9, v9, v137
    v_cvt_pk_bf16_f32 v132, v136, v137
    ds_read_b64_tr_b16 v[188:189], v219 offset:4352
    ds_read_b64_tr_b16 v[190:191], v219 offset:4864
    v_mfma_f32_32x32x16_bf16 v[80:95], v[164:167], v[128:131], 0
    v_add_f32 v138, v48, v138
    v_add_f32 v139, v48, v139
    v_exp_f32 v138, v138
    v_exp_f32 v139, v139
    v_add_f32 v8, v8, v138
    v_add_f32 v9, v9, v139
    v_cvt_pk_bf16_f32 v133, v138, v139
    s_waitcnt vmcnt(7)
    s_barrier
    ds_read_b128 v[160:163], v210 offset:17152
    s_waitcnt lgkmcnt(9)
    v_mfma_f32_32x32x16_bf16 v[96:111], v[168:171], v[128:131], 0
    v_add_f32 v140, v48, v140
    v_add_f32 v141, v48, v141
    v_exp_f32 v140, v140
    v_exp_f32 v141, v141
    v_add_f32 v8, v8, v140
    v_add_f32 v9, v9, v141
    v_cvt_pk_bf16_f32 v134, v140, v141
    ds_read_b128 v[164:167], v210 offset:17184
    v_mfma_f32_32x32x16_bf16 v[112:127], v[172:175], v[128:131], 0
    v_add_f32 v142, v48, v142
    v_add_f32 v143, v48, v143
    v_exp_f32 v142, v142
    v_exp_f32 v143, v143
    v_add_f32 v8, v8, v142
    v_add_f32 v9, v9, v143
    v_cvt_pk_bf16_f32 v135, v142, v143
    s_add_u32 s61, s75, 24576
    s_add_u32 m0, s49, 85760
    s_and_b32 s61, s61, 0x1ffff
    buffer_load_dwordx4 v5, s[32:35], s61 offen offset:0 nt lds
    ds_read_b128 v[168:171], v210 offset:17216
    s_waitcnt lgkmcnt(7)
    v_mfma_f32_32x32x16_bf16 v[64:79], v[176:179], v[132:135], v[64:79]
    v_mov_b32 v49, v48
    v_mov_b32 v50, v48
    v_mov_b32 v51, v48
    v_add_f32 v144, v48, v144
    v_add_f32 v145, v48, v145
    v_exp_f32 v144, v144
    v_exp_f32 v145, v145
    ds_read_b128 v[172:175], v210 offset:17248
    v_mfma_f32_32x32x16_bf16 v[80:95], v[180:183], v[132:135], v[80:95]
    v_mov_b32 v52, v48
    v_mov_b32 v53, v48
    v_mov_b32 v54, v48
    v_mov_b32 v55, v48
    v_add_f32 v8, v8, v144
    v_add_f32 v9, v9, v145
    v_cvt_pk_bf16_f32 v144, v144, v145
    v_add_f32 v146, v48, v146
    v_add_f32 v147, v48, v147
    v_exp_f32 v146, v146
    v_exp_f32 v147, v147
    ds_read_b128 v[176:179], v213 offset:17152
    s_waitcnt lgkmcnt(5)
    v_mfma_f32_32x32x16_bf16 v[96:111], v[184:187], v[132:135], v[96:111]
    v_mov_b32 v56, v48
    v_mov_b32 v57, v48
    v_mov_b32 v58, v48
    v_mov_b32 v59, v48
    v_add_f32 v8, v8, v146
    v_add_f32 v9, v9, v147
    v_cvt_pk_bf16_f32 v145, v146, v147
    ds_read_b128 v[180:183], v213 offset:17184
    v_mfma_f32_32x32x16_bf16 v[112:127], v[188:191], v[132:135], v[112:127]
    v_mov_b32 v60, v48
    v_mov_b32 v61, v48
    v_mov_b32 v62, v48
    v_mov_b32 v63, v48
    v_add_f32 v148, v48, v148
    v_add_f32 v149, v48, v149
    v_exp_f32 v148, v148
    v_exp_f32 v149, v149
    s_add_u32 m0, s49, 86592
    s_nop 0
    buffer_load_dwordx4 v5, s[32:35], s61 offen offset:256 nt lds
    ds_read_b128 v[184:187], v213 offset:17216
    s_waitcnt lgkmcnt(5)
    v_mfma_f32_32x32x16_bf16 v[128:143], v[160:163], v[16:19], v[48:63]
    v_add_f32 v8, v8, v148
    v_add_f32 v9, v9, v149
    v_cvt_pk_bf16_f32 v146, v148, v149
    v_add_f32 v150, v48, v150
    v_add_f32 v151, v48, v151
    v_exp_f32 v150, v150
    v_exp_f32 v151, v151
    ds_read_b128 v[188:191], v213 offset:17248
    v_mfma_f32_32x32x16_bf16 v[128:143], v[164:167], v[20:23], v[128:143]
    v_add_f32 v8, v8, v150
    v_add_f32 v9, v9, v151
    v_cvt_pk_bf16_f32 v147, v150, v151
    ds_read_b64_tr_b16 v[160:161], v216 offset:34304
    ds_read_b64_tr_b16 v[162:163], v216 offset:34816
    s_waitcnt lgkmcnt(6)
    v_mfma_f32_32x32x16_bf16 v[128:143], v[168:171], v[24:27], v[128:143]
    v_add_f32 v152, v48, v152
    v_add_f32 v153, v48, v153
    v_exp_f32 v152, v152
    v_exp_f32 v153, v153
    ds_read_b64_tr_b16 v[164:165], v216 offset:34368
    ds_read_b64_tr_b16 v[166:167], v216 offset:34880
    v_mfma_f32_32x32x16_bf16 v[128:143], v[172:175], v[28:31], v[128:143]
    v_add_f32 v8, v8, v152
    v_add_f32 v9, v9, v153
    v_cvt_pk_bf16_f32 v148, v152, v153
    v_add_f32 v154, v48, v154
    v_add_f32 v155, v48, v155
    v_exp_f32 v154, v154
    v_exp_f32 v155, v155
    s_add_u32 s60, s75, 40960
    s_add_u32 m0, s48, 34304
    s_and_b32 s60, s60, 0x1ffff
    buffer_load_dwordx4 v4, s[28:31], s60 offen offset:0 nt lds
    ds_read_b64_tr_b16 v[168:169], v219 offset:34304
    ds_read_b64_tr_b16 v[170:171], v219 offset:34816
    s_waitcnt lgkmcnt(8)
    v_mfma_f32_32x32x16_bf16 v[128:143], v[176:179], v[32:35], v[128:143]
    v_add_f32 v8, v8, v154
    v_add_f32 v9, v9, v155
    v_cvt_pk_bf16_f32 v149, v154, v155
    ds_read_b64_tr_b16 v[172:173], v219 offset:34368
    ds_read_b64_tr_b16 v[174:175], v219 offset:34880
    v_mfma_f32_32x32x16_bf16 v[128:143], v[180:183], v[36:39], v[128:143]
    v_add_f32 v156, v48, v156
    v_add_f32 v157, v48, v157
    v_exp_f32 v156, v156
    v_exp_f32 v157, v157
    ds_read_b64_tr_b16 v[176:177], v216 offset:38592
    ds_read_b64_tr_b16 v[178:179], v216 offset:39104
    s_waitcnt lgkmcnt(10)
    v_mfma_f32_32x32x16_bf16 v[128:143], v[184:187], v[40:43], v[128:143]
    v_add_f32 v8, v8, v156
    v_add_f32 v9, v9, v157
    v_cvt_pk_bf16_f32 v150, v156, v157
    v_add_f32 v158, v48, v158
    v_add_f32 v159, v48, v159
    v_exp_f32 v158, v158
    v_exp_f32 v159, v159
    ds_read_b64_tr_b16 v[180:181], v216 offset:38656
    ds_read_b64_tr_b16 v[182:183], v216 offset:39168
    v_mfma_f32_32x32x16_bf16 v[128:143], v[188:191], v[44:47], v[128:143]
    v_add_f32 v8, v8, v158
    v_add_f32 v9, v9, v159
    v_cvt_pk_bf16_f32 v151, v158, v159
    s_add_u32 m0, s48, 35088
    s_nop 0
    buffer_load_dwordx4 v4, s[28:31], s60 offen offset:256 nt lds
    ds_read_b64_tr_b16 v[184:185], v219 offset:38592
    ds_read_b64_tr_b16 v[186:187], v219 offset:39104
    s_waitcnt lgkmcnt(10)
    v_mfma_f32_32x32x16_bf16 v[64:79], v[160:163], v[144:147], v[64:79]
    ds_read_b64_tr_b16 v[188:189], v219 offset:38656
    ds_read_b64_tr_b16 v[190:191], v219 offset:39168
    v_mfma_f32_32x32x16_bf16 v[80:95], v[164:167], v[144:147], v[80:95]
    s_waitcnt vmcnt(6)
    s_barrier
    ds_read_b128 v[160:163], v208 offset:17152
    s_waitcnt lgkmcnt(9)
    v_mfma_f32_32x32x16_bf16 v[96:111], v[168:171], v[144:147], v[96:111]
    v_exp_f32 v128, v128
    v_exp_f32 v129, v129
    ds_read_b128 v[164:167], v208 offset:17184
    v_mfma_f32_32x32x16_bf16 v[112:127], v[172:175], v[144:147], v[112:127]
    v_add_f32 v8, v8, v128
    v_add_f32 v9, v9, v129
    v_cvt_pk_bf16_f32 v128, v128, v129
    s_add_u32 s61, s70, 32768
    s_add_u32 m0, s49, 68608
    s_and_b32 s61, s61, 0x1ffff
    buffer_load_dwordx4 v5, s[32:35], s61 offen offset:0 nt lds
    ds_read_b128 v[168:171], v208 offset:17216
    s_waitcnt lgkmcnt(7)
    v_mfma_f32_32x32x16_bf16 v[64:79], v[176:179], v[148:151], v[64:79]
    v_exp_f32 v130, v130
    v_exp_f32 v131, v131
    ds_read_b128 v[172:175], v208 offset:17248
    v_mfma_f32_32x32x16_bf16 v[80:95], v[180:183], v[148:151], v[80:95]
    v_add_f32 v8, v8, v130
    v_add_f32 v9, v9, v131
    v_cvt_pk_bf16_f32 v129, v130, v131
    ds_read_b128 v[176:179], v211 offset:17152
    s_waitcnt lgkmcnt(5)
    v_mfma_f32_32x32x16_bf16 v[96:111], v[184:187], v[148:151], v[96:111]
    v_exp_f32 v132, v132
    v_exp_f32 v133, v133
    ds_read_b128 v[180:183], v211 offset:17184
    v_mfma_f32_32x32x16_bf16 v[112:127], v[188:191], v[148:151], v[112:127]
    v_add_f32 v8, v8, v132
    v_add_f32 v9, v9, v133
    v_cvt_pk_bf16_f32 v130, v132, v133
    s_add_u32 m0, s49, 69440
    s_nop 0
    buffer_load_dwordx4 v5, s[32:35], s61 offen offset:256 nt lds
    ds_read_b128 v[184:187], v211 offset:17216
    s_waitcnt lgkmcnt(5)
    v_mfma_f32_32x32x16_bf16 v[144:159], v[160:163], v[16:19], v[48:63]
    v_exp_f32 v134, v134
    v_exp_f32 v135, v135
    ds_read_b128 v[188:191], v211 offset:17248
    v_mfma_f32_32x32x16_bf16 v[144:159], v[164:167], v[20:23], v[144:159]
    v_add_f32 v8, v8, v134
    v_add_f32 v9, v9, v135
    v_cvt_pk_bf16_f32 v131, v134, v135
    ds_read_b64_tr_b16 v[160:161], v214 offset:0
    ds_read_b64_tr_b16 v[162:163], v214 offset:512
    s_waitcnt lgkmcnt(6)
    v_mfma_f32_32x32x16_bf16 v[144:159], v[168:171], v[24:27], v[144:159]
    v_exp_f32 v136, v136
    v_exp_f32 v137, v137
    ds_read_b64_tr_b16 v[164:165], v214 offset:64
    ds_read_b64_tr_b16 v[166:167], v214 offset:576
    v_mfma_f32_32x32x16_bf16 v[144:159], v[172:175], v[28:31], v[144:159]
    v_add_f32 v8, v8, v136
    v_add_f32 v9, v9, v137
    v_cvt_pk_bf16_f32 v132, v136, v137
    s_add_u32 s60, s70, 49152
    s_add_u32 m0, s48, 102912
    s_and_b32 s60, s60, 0x1ffff
    buffer_load_dwordx4 v4, s[28:31], s60 offen offset:0 nt lds
    ds_read_b64_tr_b16 v[168:169], v217 offset:0
    ds_read_b64_tr_b16 v[170:171], v217 offset:512
    s_waitcnt lgkmcnt(8)
    v_mfma_f32_32x32x16_bf16 v[144:159], v[176:179], v[32:35], v[144:159]
    v_exp_f32 v138, v138
    v_exp_f32 v139, v139
    ds_read_b64_tr_b16 v[172:173], v217 offset:64
    ds_read_b64_tr_b16 v[174:175], v217 offset:576
    v_mfma_f32_32x32x16_bf16 v[144:159], v[180:183], v[36:39], v[144:159]
    v_add_f32 v8, v8, v138
    v_add_f32 v9, v9, v139
    v_cvt_pk_bf16_f32 v133, v138, v139
    ds_read_b64_tr_b16 v[176:177], v214 offset:4288
    ds_read_b64_tr_b16 v[178:179], v214 offset:4800
    s_waitcnt lgkmcnt(10)
    v_mfma_f32_32x32x16_bf16 v[144:159], v[184:187], v[40:43], v[144:159]
    v_exp_f32 v140, v140
    v_exp_f32 v141, v141
    ds_read_b64_tr_b16 v[180:181], v214 offset:4352
    ds_read_b64_tr_b16 v[182:183], v214 offset:4864
    v_mfma_f32_32x32x16_bf16 v[144:159], v[188:191], v[44:47], v[144:159]
    v_add_f32 v8, v8, v140
    v_add_f32 v9, v9, v141
    v_cvt_pk_bf16_f32 v134, v140, v141
    s_add_u32 m0, s48, 103696
    s_nop 0
    buffer_load_dwordx4 v4, s[28:31], s60 offen offset:256 nt lds
    ds_read_b64_tr_b16 v[184:185], v217 offset:4288
    ds_read_b64_tr_b16 v[186:187], v217 offset:4800
    s_waitcnt lgkmcnt(10)
    v_mfma_f32_32x32x16_bf16 v[64:79], v[160:163], v[128:131], v[64:79]
    v_exp_f32 v142, v142
    v_exp_f32 v143, v143
    ds_read_b64_tr_b16 v[188:189], v217 offset:4352
    ds_read_b64_tr_b16 v[190:191], v217 offset:4864
    v_mfma_f32_32x32x16_bf16 v[80:95], v[164:167], v[128:131], v[80:95]
    v_add_f32 v8, v8, v142
    v_add_f32 v9, v9, v143
    v_cvt_pk_bf16_f32 v135, v142, v143
    s_waitcnt vmcnt(6)
    s_barrier
    ds_read_b128 v[160:163], v209 offset:0
    s_waitcnt lgkmcnt(9)
    v_mfma_f32_32x32x16_bf16 v[96:111], v[168:171], v[128:131], v[96:111]
    v_exp_f32 v144, v144
    v_exp_f32 v145, v145
    ds_read_b128 v[164:167], v209 offset:32
    v_mfma_f32_32x32x16_bf16 v[112:127], v[172:175], v[128:131], v[112:127]
    v_add_f32 v8, v8, v144
    v_add_f32 v9, v9, v145
    v_cvt_pk_bf16_f32 v144, v144, v145
    s_add_u32 s61, s75, 40960
    s_add_u32 m0, s49, 120064
    s_and_b32 s61, s61, 0x1ffff
    buffer_load_dwordx4 v5, s[32:35], s61 offen offset:0 nt lds
    ds_read_b128 v[168:171], v209 offset:64
    s_waitcnt lgkmcnt(7)
    v_mfma_f32_32x32x16_bf16 v[64:79], v[176:179], v[132:135], v[64:79]
    v_exp_f32 v146, v146
    v_exp_f32 v147, v147
    ds_read_b128 v[172:175], v209 offset:96
    v_mfma_f32_32x32x16_bf16 v[80:95], v[180:183], v[132:135], v[80:95]
    v_add_f32 v8, v8, v146
    v_add_f32 v9, v9, v147
    v_cvt_pk_bf16_f32 v145, v146, v147
    ds_read_b128 v[176:179], v212 offset:0
    s_waitcnt lgkmcnt(5)
    v_mfma_f32_32x32x16_bf16 v[96:111], v[184:187], v[132:135], v[96:111]
    v_exp_f32 v148, v148
    v_exp_f32 v149, v149
    ds_read_b128 v[180:183], v212 offset:32
    v_mfma_f32_32x32x16_bf16 v[112:127], v[188:191], v[132:135], v[112:127]
    v_add_f32 v8, v8, v148
    v_add_f32 v9, v9, v149
    v_cvt_pk_bf16_f32 v146, v148, v149
    s_add_u32 m0, s49, 120896
    s_nop 0
    buffer_load_dwordx4 v5, s[32:35], s61 offen offset:256 nt lds
    ds_read_b128 v[184:187], v212 offset:64
    s_waitcnt lgkmcnt(5)
    v_mfma_f32_32x32x16_bf16 v[128:143], v[160:163], v[16:19], v[48:63]
    v_exp_f32 v150, v150
    v_exp_f32 v151, v151
    ds_read_b128 v[188:191], v212 offset:96
    v_mfma_f32_32x32x16_bf16 v[128:143], v[164:167], v[20:23], v[128:143]
    v_add_f32 v8, v8, v150
    v_add_f32 v9, v9, v151
    v_cvt_pk_bf16_f32 v147, v150, v151
    ds_read_b64_tr_b16 v[160:161], v215 offset:34304
    ds_read_b64_tr_b16 v[162:163], v215 offset:34816
    s_waitcnt lgkmcnt(6)
    v_mfma_f32_32x32x16_bf16 v[128:143], v[168:171], v[24:27], v[128:143]
    v_exp_f32 v152, v152
    v_exp_f32 v153, v153
    ds_read_b64_tr_b16 v[164:165], v215 offset:34368
    ds_read_b64_tr_b16 v[166:167], v215 offset:34880
    v_mfma_f32_32x32x16_bf16 v[128:143], v[172:175], v[28:31], v[128:143]
    v_add_f32 v8, v8, v152
    v_add_f32 v9, v9, v153
    v_cvt_pk_bf16_f32 v148, v152, v153
    s_add_u32 s60, s75, 57344
    s_add_u32 m0, s48, 137216
    s_and_b32 s60, s60, 0x1ffff
    buffer_load_dwordx4 v4, s[28:31], s60 offen offset:0 nt lds
    ds_read_b64_tr_b16 v[168:169], v218 offset:34304
    ds_read_b64_tr_b16 v[170:171], v218 offset:34816
    s_waitcnt lgkmcnt(8)
    v_mfma_f32_32x32x16_bf16 v[128:143], v[176:179], v[32:35], v[128:143]
    v_exp_f32 v154, v154
    v_exp_f32 v155, v155
    ds_read_b64_tr_b16 v[172:173], v218 offset:34368
    ds_read_b64_tr_b16 v[174:175], v218 offset:34880
    v_mfma_f32_32x32x16_bf16 v[128:143], v[180:183], v[36:39], v[128:143]
    v_add_f32 v8, v8, v154
    v_add_f32 v9, v9, v155
    v_cvt_pk_bf16_f32 v149, v154, v155
    ds_read_b64_tr_b16 v[176:177], v215 offset:38592
    ds_read_b64_tr_b16 v[178:179], v215 offset:39104
    s_waitcnt lgkmcnt(10)
    v_mfma_f32_32x32x16_bf16 v[128:143], v[184:187], v[40:43], v[128:143]
    v_exp_f32 v156, v156
    v_exp_f32 v157, v157
    ds_read_b64_tr_b16 v[180:181], v215 offset:38656
    ds_read_b64_tr_b16 v[182:183], v215 offset:39168
    v_mfma_f32_32x32x16_bf16 v[128:143], v[188:191], v[44:47], v[128:143]
    v_add_f32 v8, v8, v156
    v_add_f32 v9, v9, v157
    v_cvt_pk_bf16_f32 v150, v156, v157
    s_add_u32 m0, s48, 138000
    s_nop 0
    buffer_load_dwordx4 v4, s[28:31], s60 offen offset:256 nt lds
    ds_read_b64_tr_b16 v[184:185], v218 offset:38592
    ds_read_b64_tr_b16 v[186:187], v218 offset:39104
    s_waitcnt lgkmcnt(10)
    v_mfma_f32_32x32x16_bf16 v[64:79], v[160:163], v[144:147], v[64:79]
    v_exp_f32 v158, v158
    v_exp_f32 v159, v159
    ds_read_b64_tr_b16 v[188:189], v218 offset:38656
    ds_read_b64_tr_b16 v[190:191], v218 offset:39168
    v_mfma_f32_32x32x16_bf16 v[80:95], v[164:167], v[144:147], v[80:95]
    v_add_f32 v8, v8, v158
    v_add_f32 v9, v9, v159
    v_cvt_pk_bf16_f32 v151, v158, v159
    s_waitcnt vmcnt(6)
    s_barrier
    ds_read_b128 v[160:163], v208 offset:34304
    s_waitcnt lgkmcnt(9)
    v_mfma_f32_32x32x16_bf16 v[96:111], v[168:171], v[144:147], v[96:111]
    v_exp_f32 v128, v128
    v_exp_f32 v129, v129
    ds_read_b128 v[164:167], v208 offset:34336
    v_mfma_f32_32x32x16_bf16 v[112:127], v[172:175], v[144:147], v[112:127]
    v_add_f32 v8, v8, v128
    v_add_f32 v9, v9, v129
    v_cvt_pk_bf16_f32 v128, v128, v129
    s_add_u32 s61, s70, 49152
    s_add_u32 m0, s49, 17152
    s_and_b32 s61, s61, 0x1ffff
    buffer_load_dwordx4 v5, s[32:35], s61 offen offset:0 nt lds
    ds_read_b128 v[168:171], v208 offset:34368
    s_waitcnt lgkmcnt(7)
    v_mfma_f32_32x32x16_bf16 v[64:79], v[176:179], v[148:151], v[64:79]
    v_exp_f32 v130, v130
    v_exp_f32 v131, v131
    ds_read_b128 v[172:175], v208 offset:34400
    v_mfma_f32_32x32x16_bf16 v[80:95], v[180:183], v[148:151], v[80:95]
    v_add_f32 v8, v8, v130
    v_add_f32 v9, v9, v131
    v_cvt_pk_bf16_f32 v129, v130, v131
    ds_read_b128 v[176:179], v211 offset:34304
    s_waitcnt lgkmcnt(5)
    v_mfma_f32_32x32x16_bf16 v[96:111], v[184:187], v[148:151], v[96:111]
    v_exp_f32 v132, v132
    v_exp_f32 v133, v133
    ds_read_b128 v[180:183], v211 offset:34336
    v_mfma_f32_32x32x16_bf16 v[112:127], v[188:191], v[148:151], v[112:127]
    v_add_f32 v8, v8, v132
    v_add_f32 v9, v9, v133
    v_cvt_pk_bf16_f32 v130, v132, v133
    s_add_u32 m0, s49, 17984
    s_nop 0
    buffer_load_dwordx4 v5, s[32:35], s61 offen offset:256 nt lds
    ds_read_b128 v[184:187], v211 offset:34368
    s_waitcnt lgkmcnt(5)
    v_mfma_f32_32x32x16_bf16 v[144:159], v[160:163], v[16:19], v[48:63]
    v_exp_f32 v134, v134
    v_exp_f32 v135, v135
    ds_read_b128 v[188:191], v211 offset:34400
    v_mfma_f32_32x32x16_bf16 v[144:159], v[164:167], v[20:23], v[144:159]
    v_add_f32 v8, v8, v134
    v_add_f32 v9, v9, v135
    v_cvt_pk_bf16_f32 v131, v134, v135
    ds_read_b64_tr_b16 v[160:161], v215 offset:17152
    ds_read_b64_tr_b16 v[162:163], v215 offset:17664
    s_waitcnt lgkmcnt(6)
    v_mfma_f32_32x32x16_bf16 v[144:159], v[168:171], v[24:27], v[144:159]
    v_exp_f32 v136, v136
    v_exp_f32 v137, v137
    ds_read_b64_tr_b16 v[164:165], v215 offset:17216
    ds_read_b64_tr_b16 v[166:167], v215 offset:17728
    v_mfma_f32_32x32x16_bf16 v[144:159], v[172:175], v[28:31], v[144:159]
    v_add_f32 v8, v8, v136
    v_add_f32 v9, v9, v137
    v_cvt_pk_bf16_f32 v132, v136, v137
    s_add_u32 s60, s70, 65536
    s_add_u32 m0, s48, 0
    s_and_b32 s60, s60, 0x1ffff
    buffer_load_dwordx4 v4, s[28:31], s60 offen offset:0 nt lds
    ds_read_b64_tr_b16 v[168:169], v218 offset:17152
    ds_read_b64_tr_b16 v[170:171], v218 offset:17664
    s_waitcnt lgkmcnt(8)
    v_mfma_f32_32x32x16_bf16 v[144:159], v[176:179], v[32:35], v[144:159]
    v_exp_f32 v138, v138
    v_exp_f32 v139, v139
    ds_read_b64_tr_b16 v[172:173], v218 offset:17216
    ds_read_b64_tr_b16 v[174:175], v218 offset:17728
    v_mfma_f32_32x32x16_bf16 v[144:159], v[180:183], v[36:39], v[144:159]
    v_add_f32 v8, v8, v138
    v_add_f32 v9, v9, v139
    v_cvt_pk_bf16_f32 v133, v138, v139
    ds_read_b64_tr_b16 v[176:177], v215 offset:21440
    ds_read_b64_tr_b16 v[178:179], v215 offset:21952
    s_waitcnt lgkmcnt(10)
    v_mfma_f32_32x32x16_bf16 v[144:159], v[184:187], v[40:43], v[144:159]
    v_exp_f32 v140, v140
    v_exp_f32 v141, v141
    ds_read_b64_tr_b16 v[180:181], v215 offset:21504
    ds_read_b64_tr_b16 v[182:183], v215 offset:22016
    v_mfma_f32_32x32x16_bf16 v[144:159], v[188:191], v[44:47], v[144:159]
    v_add_f32 v8, v8, v140
    v_add_f32 v9, v9, v141
    v_cvt_pk_bf16_f32 v134, v140, v141
    s_add_u32 m0, s48, 784
    s_nop 0
    buffer_load_dwordx4 v4, s[28:31], s60 offen offset:256 nt lds
    ds_read_b64_tr_b16 v[184:185], v218 offset:21440
    ds_read_b64_tr_b16 v[186:187], v218 offset:21952
    s_waitcnt lgkmcnt(10)
    v_mfma_f32_32x32x16_bf16 v[64:79], v[160:163], v[128:131], v[64:79]
    v_exp_f32 v142, v142
    v_exp_f32 v143, v143
    ds_read_b64_tr_b16 v[188:189], v218 offset:21504
    ds_read_b64_tr_b16 v[190:191], v218 offset:22016
    v_mfma_f32_32x32x16_bf16 v[80:95], v[164:167], v[128:131], v[80:95]
    v_add_f32 v8, v8, v142
    v_add_f32 v9, v9, v143
    v_cvt_pk_bf16_f32 v135, v142, v143
    s_waitcnt vmcnt(6)
    s_barrier
    ds_read_b128 v[160:163], v210 offset:0
    s_waitcnt lgkmcnt(9)
    v_mfma_f32_32x32x16_bf16 v[96:111], v[168:171], v[128:131], v[96:111]
    v_exp_f32 v144, v144
    v_exp_f32 v145, v145
    ds_read_b128 v[164:167], v210 offset:32
    v_mfma_f32_32x32x16_bf16 v[112:127], v[172:175], v[128:131], v[112:127]
    v_add_f32 v8, v8, v144
    v_add_f32 v9, v9, v145
    v_cvt_pk_bf16_f32 v144, v144, v145
    s_add_u32 s61, s75, 57344
    s_add_u32 m0, s49, 51456
    s_and_b32 s61, s61, 0x1ffff
    buffer_load_dwordx4 v5, s[32:35], s61 offen offset:0 nt lds
    ds_read_b128 v[168:171], v210 offset:64
    s_waitcnt lgkmcnt(7)
    v_mfma_f32_32x32x16_bf16 v[64:79], v[176:179], v[132:135], v[64:79]
    v_exp_f32 v146, v146
    v_exp_f32 v147, v147
    ds_read_b128 v[172:175], v210 offset:96
    v_mfma_f32_32x32x16_bf16 v[80:95], v[180:183], v[132:135], v[80:95]
    v_add_f32 v8, v8, v146
    v_add_f32 v9, v9, v147
    v_cvt_pk_bf16_f32 v145, v146, v147
    ds_read_b128 v[176:179], v213 offset:0
    s_waitcnt lgkmcnt(5)
    v_mfma_f32_32x32x16_bf16 v[96:111], v[184:187], v[132:135], v[96:111]
    v_exp_f32 v148, v148
    v_exp_f32 v149, v149
    ds_read_b128 v[180:183], v213 offset:32
    v_mfma_f32_32x32x16_bf16 v[112:127], v[188:191], v[132:135], v[112:127]
    v_add_f32 v8, v8, v148
    v_add_f32 v9, v9, v149
    v_cvt_pk_bf16_f32 v146, v148, v149
    s_add_u32 m0, s49, 52288
    s_nop 0
    buffer_load_dwordx4 v5, s[32:35], s61 offen offset:256 nt lds
    ds_read_b128 v[184:187], v213 offset:64
    s_waitcnt lgkmcnt(5)
    v_mfma_f32_32x32x16_bf16 v[128:143], v[160:163], v[16:19], v[48:63]
    v_exp_f32 v150, v150
    v_exp_f32 v151, v151
    ds_read_b128 v[188:191], v213 offset:96
    v_mfma_f32_32x32x16_bf16 v[128:143], v[164:167], v[20:23], v[128:143]
    v_add_f32 v8, v8, v150
    v_add_f32 v9, v9, v151
    v_cvt_pk_bf16_f32 v147, v150, v151
    ds_read_b64_tr_b16 v[160:161], v216 offset:17152
    ds_read_b64_tr_b16 v[162:163], v216 offset:17664
    s_waitcnt lgkmcnt(6)
    v_mfma_f32_32x32x16_bf16 v[128:143], v[168:171], v[24:27], v[128:143]
    v_exp_f32 v152, v152
    v_exp_f32 v153, v153
    ds_read_b64_tr_b16 v[164:165], v216 offset:17216
    ds_read_b64_tr_b16 v[166:167], v216 offset:17728
    v_mfma_f32_32x32x16_bf16 v[128:143], v[172:175], v[28:31], v[128:143]
    v_add_f32 v8, v8, v152
    v_add_f32 v9, v9, v153
    v_cvt_pk_bf16_f32 v148, v152, v153
    s_add_u32 s60, s75, 73728
    s_add_u32 m0, s48, 85760
    s_and_b32 s60, s60, 0x1ffff
    buffer_load_dwordx4 v4, s[28:31], s60 offen offset:0 nt lds
    ds_read_b64_tr_b16 v[168:169], v219 offset:17152
    ds_read_b64_tr_b16 v[170:171], v219 offset:17664
    s_waitcnt lgkmcnt(8)
    v_mfma_f32_32x32x16_bf16 v[128:143], v[176:179], v[32:35], v[128:143]
    v_exp_f32 v154, v154
    v_exp_f32 v155, v155
    ds_read_b64_tr_b16 v[172:173], v219 offset:17216
    ds_read_b64_tr_b16 v[174:175], v219 offset:17728
    v_mfma_f32_32x32x16_bf16 v[128:143], v[180:183], v[36:39], v[128:143]
    v_add_f32 v8, v8, v154
    v_add_f32 v9, v9, v155
    v_cvt_pk_bf16_f32 v149, v154, v155
    ds_read_b64_tr_b16 v[176:177], v216 offset:21440
    ds_read_b64_tr_b16 v[178:179], v216 offset:21952
    s_waitcnt lgkmcnt(10)
    v_mfma_f32_32x32x16_bf16 v[128:143], v[184:187], v[40:43], v[128:143]
    v_exp_f32 v156, v156
    v_exp_f32 v157, v157
    ds_read_b64_tr_b16 v[180:181], v216 offset:21504
    ds_read_b64_tr_b16 v[182:183], v216 offset:22016
    v_mfma_f32_32x32x16_bf16 v[128:143], v[188:191], v[44:47], v[128:143]
    v_add_f32 v8, v8, v156
    v_add_f32 v9, v9, v157
    v_cvt_pk_bf16_f32 v150, v156, v157
    s_add_u32 m0, s48, 86544
    s_nop 0
    buffer_load_dwordx4 v4, s[28:31], s60 offen offset:256 nt lds
    ds_read_b64_tr_b16 v[184:185], v219 offset:21440
    ds_read_b64_tr_b16 v[186:187], v219 offset:21952
    s_waitcnt lgkmcnt(10)
    v_mfma_f32_32x32x16_bf16 v[64:79], v[160:163], v[144:147], v[64:79]
    v_exp_f32 v158, v158
    v_exp_f32 v159, v159
    ds_read_b64_tr_b16 v[188:189], v219 offset:21504
    ds_read_b64_tr_b16 v[190:191], v219 offset:22016
    v_mfma_f32_32x32x16_bf16 v[80:95], v[164:167], v[144:147], v[80:95]
    v_add_f32 v8, v8, v158
    v_add_f32 v9, v9, v159
    v_cvt_pk_bf16_f32 v151, v158, v159
    s_waitcnt vmcnt(6)
    s_barrier
    ds_read_b128 v[160:163], v210 offset:34304
    s_waitcnt lgkmcnt(9)
    v_mfma_f32_32x32x16_bf16 v[96:111], v[168:171], v[144:147], v[96:111]
    v_exp_f32 v128, v128
    v_exp_f32 v129, v129
    ds_read_b128 v[164:167], v210 offset:34336
    v_mfma_f32_32x32x16_bf16 v[112:127], v[172:175], v[144:147], v[112:127]
    v_add_f32 v8, v8, v128
    v_add_f32 v9, v9, v129
    v_cvt_pk_bf16_f32 v128, v128, v129
    s_add_u32 s61, s70, 65536
    s_add_u32 m0, s49, 34304
    s_and_b32 s61, s61, 0x1ffff
    buffer_load_dwordx4 v5, s[32:35], s61 offen offset:0 nt lds
    ds_read_b128 v[168:171], v210 offset:34368
    s_waitcnt lgkmcnt(7)
    v_mfma_f32_32x32x16_bf16 v[64:79], v[176:179], v[148:151], v[64:79]
    v_exp_f32 v130, v130
    v_exp_f32 v131, v131
    ds_read_b128 v[172:175], v210 offset:34400
    v_mfma_f32_32x32x16_bf16 v[80:95], v[180:183], v[148:151], v[80:95]
    v_add_f32 v8, v8, v130
    v_add_f32 v9, v9, v131
    v_cvt_pk_bf16_f32 v129, v130, v131
    ds_read_b128 v[176:179], v213 offset:34304
    s_waitcnt lgkmcnt(5)
    v_mfma_f32_32x32x16_bf16 v[96:111], v[184:187], v[148:151], v[96:111]
    v_exp_f32 v132, v132
    v_exp_f32 v133, v133
    ds_read_b128 v[180:183], v213 offset:34336
    v_mfma_f32_32x32x16_bf16 v[112:127], v[188:191], v[148:151], v[112:127]
    v_add_f32 v8, v8, v132
    v_add_f32 v9, v9, v133
    v_cvt_pk_bf16_f32 v130, v132, v133
    s_add_u32 m0, s49, 35136
    s_nop 0
    buffer_load_dwordx4 v5, s[32:35], s61 offen offset:256 nt lds
    ds_read_b128 v[184:187], v213 offset:34368
    s_waitcnt lgkmcnt(5)
    v_mfma_f32_32x32x16_bf16 v[144:159], v[160:163], v[16:19], v[48:63]
    v_exp_f32 v134, v134
    v_exp_f32 v135, v135
    ds_read_b128 v[188:191], v213 offset:34400
    v_mfma_f32_32x32x16_bf16 v[144:159], v[164:167], v[20:23], v[144:159]
    v_add_f32 v8, v8, v134
    v_add_f32 v9, v9, v135
    v_cvt_pk_bf16_f32 v131, v134, v135
    ds_read_b64_tr_b16 v[160:161], v214 offset:17152
    ds_read_b64_tr_b16 v[162:163], v214 offset:17664
    s_waitcnt lgkmcnt(6)
    v_mfma_f32_32x32x16_bf16 v[144:159], v[168:171], v[24:27], v[144:159]
    v_exp_f32 v136, v136
    v_exp_f32 v137, v137
    ds_read_b64_tr_b16 v[164:165], v214 offset:17216
    ds_read_b64_tr_b16 v[166:167], v214 offset:17728
    v_mfma_f32_32x32x16_bf16 v[144:159], v[172:175], v[28:31], v[144:159]
    v_add_f32 v8, v8, v136
    v_add_f32 v9, v9, v137
    v_cvt_pk_bf16_f32 v132, v136, v137
    s_add_u32 s60, s70, 81920
    s_add_u32 m0, s48, 68608
    s_and_b32 s60, s60, 0x1ffff
    buffer_load_dwordx4 v4, s[28:31], s60 offen offset:0 nt lds
    ds_read_b64_tr_b16 v[168:169], v217 offset:17152
    ds_read_b64_tr_b16 v[170:171], v217 offset:17664
    s_waitcnt lgkmcnt(8)
    v_mfma_f32_32x32x16_bf16 v[144:159], v[176:179], v[32:35], v[144:159]
    v_exp_f32 v138, v138
    v_exp_f32 v139, v139
    ds_read_b64_tr_b16 v[172:173], v217 offset:17216
    ds_read_b64_tr_b16 v[174:175], v217 offset:17728
    v_mfma_f32_32x32x16_bf16 v[144:159], v[180:183], v[36:39], v[144:159]
    v_add_f32 v8, v8, v138
    v_add_f32 v9, v9, v139
    v_cvt_pk_bf16_f32 v133, v138, v139
    ds_read_b64_tr_b16 v[176:177], v214 offset:21440
    ds_read_b64_tr_b16 v[178:179], v214 offset:21952
    s_waitcnt lgkmcnt(10)
    v_mfma_f32_32x32x16_bf16 v[144:159], v[184:187], v[40:43], v[144:159]
    v_exp_f32 v140, v140
    v_exp_f32 v141, v141
    ds_read_b64_tr_b16 v[180:181], v214 offset:21504
    ds_read_b64_tr_b16 v[182:183], v214 offset:22016
    v_mfma_f32_32x32x16_bf16 v[144:159], v[188:191], v[44:47], v[144:159]
    v_add_f32 v8, v8, v140
    v_add_f32 v9, v9, v141
    v_cvt_pk_bf16_f32 v134, v140, v141
    s_add_u32 m0, s48, 69392
    s_nop 0
    buffer_load_dwordx4 v4, s[28:31], s60 offen offset:256 nt lds
    ds_read_b64_tr_b16 v[184:185], v217 offset:21440
    ds_read_b64_tr_b16 v[186:187], v217 offset:21952
    s_waitcnt lgkmcnt(10)
    v_mfma_f32_32x32x16_bf16 v[64:79], v[160:163], v[128:131], v[64:79]
    v_exp_f32 v142, v142
    v_exp_f32 v143, v143
    ds_read_b64_tr_b16 v[188:189], v217 offset:21504
    ds_read_b64_tr_b16 v[190:191], v217 offset:22016
    v_mfma_f32_32x32x16_bf16 v[80:95], v[164:167], v[128:131], v[80:95]
    v_add_f32 v8, v8, v142
    v_add_f32 v9, v9, v143
    v_cvt_pk_bf16_f32 v135, v142, v143
    s_waitcnt vmcnt(6)
    s_barrier
    ds_read_b128 v[160:163], v208 offset:0
    s_waitcnt lgkmcnt(9)
    v_mfma_f32_32x32x16_bf16 v[96:111], v[168:171], v[128:131], v[96:111]
    v_exp_f32 v144, v144
    v_exp_f32 v145, v145
    ds_read_b128 v[164:167], v208 offset:32
    v_mfma_f32_32x32x16_bf16 v[112:127], v[172:175], v[128:131], v[112:127]
    v_add_f32 v8, v8, v144
    v_add_f32 v9, v9, v145
    v_cvt_pk_bf16_f32 v144, v144, v145
    s_add_u32 s61, s75, 73728
    s_add_u32 m0, s49, 102912
    s_and_b32 s61, s61, 0x1ffff
    buffer_load_dwordx4 v5, s[32:35], s61 offen offset:0 nt lds
    ds_read_b128 v[168:171], v208 offset:64
    s_waitcnt lgkmcnt(7)
    v_mfma_f32_32x32x16_bf16 v[64:79], v[176:179], v[132:135], v[64:79]
    v_exp_f32 v146, v146
    v_exp_f32 v147, v147
    ds_read_b128 v[172:175], v208 offset:96
    v_mfma_f32_32x32x16_bf16 v[80:95], v[180:183], v[132:135], v[80:95]
    v_add_f32 v8, v8, v146
    v_add_f32 v9, v9, v147
    v_cvt_pk_bf16_f32 v145, v146, v147
    ds_read_b128 v[176:179], v211 offset:0
    s_waitcnt lgkmcnt(5)
    v_mfma_f32_32x32x16_bf16 v[96:111], v[184:187], v[132:135], v[96:111]
    v_exp_f32 v148, v148
    v_exp_f32 v149, v149
    ds_read_b128 v[180:183], v211 offset:32
    v_mfma_f32_32x32x16_bf16 v[112:127], v[188:191], v[132:135], v[112:127]
    v_add_f32 v8, v8, v148
    v_add_f32 v9, v9, v149
    v_cvt_pk_bf16_f32 v146, v148, v149
    s_add_u32 m0, s49, 103744
    s_nop 0
    buffer_load_dwordx4 v5, s[32:35], s61 offen offset:256 nt lds
    ds_read_b128 v[184:187], v211 offset:64
    s_waitcnt lgkmcnt(5)
    v_mfma_f32_32x32x16_bf16 v[128:143], v[160:163], v[16:19], v[48:63]
    v_exp_f32 v150, v150
    v_exp_f32 v151, v151
    ds_read_b128 v[188:191], v211 offset:96
    v_mfma_f32_32x32x16_bf16 v[128:143], v[164:167], v[20:23], v[128:143]
    v_add_f32 v8, v8, v150
    v_add_f32 v9, v9, v151
    v_cvt_pk_bf16_f32 v147, v150, v151
    ds_read_b64_tr_b16 v[160:161], v215 offset:0
    ds_read_b64_tr_b16 v[162:163], v215 offset:512
    s_waitcnt lgkmcnt(6)
    v_mfma_f32_32x32x16_bf16 v[128:143], v[168:171], v[24:27], v[128:143]
    v_exp_f32 v152, v152
    v_exp_f32 v153, v153
    ds_read_b64_tr_b16 v[164:165], v215 offset:64
    ds_read_b64_tr_b16 v[166:167], v215 offset:576
    v_mfma_f32_32x32x16_bf16 v[128:143], v[172:175], v[28:31], v[128:143]
    v_add_f32 v8, v8, v152
    v_add_f32 v9, v9, v153
    v_cvt_pk_bf16_f32 v148, v152, v153
    s_add_u32 s60, s75, 90112
    s_add_u32 m0, s48, 120064
    s_and_b32 s60, s60, 0x1ffff
    buffer_load_dwordx4 v4, s[28:31], s60 offen offset:0 nt lds
    ds_read_b64_tr_b16 v[168:169], v218 offset:0
    ds_read_b64_tr_b16 v[170:171], v218 offset:512
    s_waitcnt lgkmcnt(8)
    v_mfma_f32_32x32x16_bf16 v[128:143], v[176:179], v[32:35], v[128:143]
    v_exp_f32 v154, v154
    v_exp_f32 v155, v155
    ds_read_b64_tr_b16 v[172:173], v218 offset:64
    ds_read_b64_tr_b16 v[174:175], v218 offset:576
    v_mfma_f32_32x32x16_bf16 v[128:143], v[180:183], v[36:39], v[128:143]
    v_add_f32 v8, v8, v154
    v_add_f32 v9, v9, v155
    v_cvt_pk_bf16_f32 v149, v154, v155
    ds_read_b64_tr_b16 v[176:177], v215 offset:4288
    ds_read_b64_tr_b16 v[178:179], v215 offset:4800
    s_waitcnt lgkmcnt(10)
    v_mfma_f32_32x32x16_bf16 v[128:143], v[184:187], v[40:43], v[128:143]
    v_exp_f32 v156, v156
    v_exp_f32 v157, v157
    ds_read_b64_tr_b16 v[180:181], v215 offset:4352
    ds_read_b64_tr_b16 v[182:183], v215 offset:4864
    v_mfma_f32_32x32x16_bf16 v[128:143], v[188:191], v[44:47], v[128:143]
    v_add_f32 v8, v8, v156
    v_add_f32 v9, v9, v157
    v_cvt_pk_bf16_f32 v150, v156, v157
    s_add_u32 m0, s48, 120848
    s_nop 0
    buffer_load_dwordx4 v4, s[28:31], s60 offen offset:256 nt lds
    ds_read_b64_tr_b16 v[184:185], v218 offset:4288
    ds_read_b64_tr_b16 v[186:187], v218 offset:4800
    s_waitcnt lgkmcnt(10)
    v_mfma_f32_32x32x16_bf16 v[64:79], v[160:163], v[144:147], v[64:79]
    v_exp_f32 v158, v158
    v_exp_f32 v159, v159
    ds_read_b64_tr_b16 v[188:189], v218 offset:4352
    ds_read_b64_tr_b16 v[190:191], v218 offset:4864
    v_mfma_f32_32x32x16_bf16 v[80:95], v[164:167], v[144:147], v[80:95]
    v_add_f32 v8, v8, v158
    v_add_f32 v9, v9, v159
    v_cvt_pk_bf16_f32 v151, v158, v159
    s_waitcnt vmcnt(6)
    s_barrier
    ds_read_b128 v[160:163], v209 offset:34304
    s_waitcnt lgkmcnt(9)
    v_mfma_f32_32x32x16_bf16 v[96:111], v[168:171], v[144:147], v[96:111]
    v_exp_f32 v128, v128
    v_exp_f32 v129, v129
    ds_read_b128 v[164:167], v209 offset:34336
    v_mfma_f32_32x32x16_bf16 v[112:127], v[172:175], v[144:147], v[112:127]
    v_add_f32 v8, v8, v128
    v_add_f32 v9, v9, v129
    v_cvt_pk_bf16_f32 v128, v128, v129
    s_add_u32 s61, s70, 81920
    s_add_u32 m0, s49, 137216
    s_and_b32 s61, s61, 0x1ffff
    buffer_load_dwordx4 v5, s[32:35], s61 offen offset:0 nt lds
    ds_read_b128 v[168:171], v209 offset:34368
    s_waitcnt lgkmcnt(7)
    v_mfma_f32_32x32x16_bf16 v[64:79], v[176:179], v[148:151], v[64:79]
    v_exp_f32 v130, v130
    v_exp_f32 v131, v131
    ds_read_b128 v[172:175], v209 offset:34400
    v_mfma_f32_32x32x16_bf16 v[80:95], v[180:183], v[148:151], v[80:95]
    v_add_f32 v8, v8, v130
    v_add_f32 v9, v9, v131
    v_cvt_pk_bf16_f32 v129, v130, v131
    ds_read_b128 v[176:179], v212 offset:34304
    s_waitcnt lgkmcnt(5)
    v_mfma_f32_32x32x16_bf16 v[96:111], v[184:187], v[148:151], v[96:111]
    v_exp_f32 v132, v132
    v_exp_f32 v133, v133
    ds_read_b128 v[180:183], v212 offset:34336
    v_mfma_f32_32x32x16_bf16 v[112:127], v[188:191], v[148:151], v[112:127]
    v_add_f32 v8, v8, v132
    v_add_f32 v9, v9, v133
    v_cvt_pk_bf16_f32 v130, v132, v133
    s_add_u32 m0, s49, 138048
    s_nop 0
    buffer_load_dwordx4 v5, s[32:35], s61 offen offset:256 nt lds
    ds_read_b128 v[184:187], v212 offset:34368
    s_waitcnt lgkmcnt(5)
    v_mfma_f32_32x32x16_bf16 v[144:159], v[160:163], v[16:19], v[48:63]
    v_exp_f32 v134, v134
    v_exp_f32 v135, v135
    ds_read_b128 v[188:191], v212 offset:34400
    v_mfma_f32_32x32x16_bf16 v[144:159], v[164:167], v[20:23], v[144:159]
    v_add_f32 v8, v8, v134
    v_add_f32 v9, v9, v135
    v_cvt_pk_bf16_f32 v131, v134, v135
    ds_read_b64_tr_b16 v[160:161], v214 offset:34304
    ds_read_b64_tr_b16 v[162:163], v214 offset:34816
    s_waitcnt lgkmcnt(6)
    v_mfma_f32_32x32x16_bf16 v[144:159], v[168:171], v[24:27], v[144:159]
    v_exp_f32 v136, v136
    v_exp_f32 v137, v137
    ds_read_b64_tr_b16 v[164:165], v214 offset:34368
    ds_read_b64_tr_b16 v[166:167], v214 offset:34880
    v_mfma_f32_32x32x16_bf16 v[144:159], v[172:175], v[28:31], v[144:159]
    v_add_f32 v8, v8, v136
    v_add_f32 v9, v9, v137
    v_cvt_pk_bf16_f32 v132, v136, v137
    s_add_u32 s60, s70, 98304
    s_add_u32 m0, s48, 17152
    s_and_b32 s60, s60, 0x1ffff
    buffer_load_dwordx4 v4, s[28:31], s60 offen offset:0 nt lds
    ds_read_b64_tr_b16 v[168:169], v217 offset:34304
    ds_read_b64_tr_b16 v[170:171], v217 offset:34816
    s_waitcnt lgkmcnt(8)
    v_mfma_f32_32x32x16_bf16 v[144:159], v[176:179], v[32:35], v[144:159]
    v_exp_f32 v138, v138
    v_exp_f32 v139, v139
    ds_read_b64_tr_b16 v[172:173], v217 offset:34368
    ds_read_b64_tr_b16 v[174:175], v217 offset:34880
    v_mfma_f32_32x32x16_bf16 v[144:159], v[180:183], v[36:39], v[144:159]
    v_add_f32 v8, v8, v138
    v_add_f32 v9, v9, v139
    v_cvt_pk_bf16_f32 v133, v138, v139
    ds_read_b64_tr_b16 v[176:177], v214 offset:38592
    ds_read_b64_tr_b16 v[178:179], v214 offset:39104
    s_waitcnt lgkmcnt(10)
    v_mfma_f32_32x32x16_bf16 v[144:159], v[184:187], v[40:43], v[144:159]
    v_exp_f32 v140, v140
    v_exp_f32 v141, v141
    ds_read_b64_tr_b16 v[180:181], v214 offset:38656
    ds_read_b64_tr_b16 v[182:183], v214 offset:39168
    v_mfma_f32_32x32x16_bf16 v[144:159], v[188:191], v[44:47], v[144:159]
    v_add_f32 v8, v8, v140
    v_add_f32 v9, v9, v141
    v_cvt_pk_bf16_f32 v134, v140, v141
    s_add_u32 m0, s48, 17936
    s_nop 0
    buffer_load_dwordx4 v4, s[28:31], s60 offen offset:256 nt lds
    ds_read_b64_tr_b16 v[184:185], v217 offset:38592
    ds_read_b64_tr_b16 v[186:187], v217 offset:39104
    s_waitcnt lgkmcnt(10)
    v_mfma_f32_32x32x16_bf16 v[64:79], v[160:163], v[128:131], v[64:79]
    v_exp_f32 v142, v142
    v_exp_f32 v143, v143
    ds_read_b64_tr_b16 v[188:189], v217 offset:38656
    ds_read_b64_tr_b16 v[190:191], v217 offset:39168
    v_mfma_f32_32x32x16_bf16 v[80:95], v[164:167], v[128:131], v[80:95]
    v_add_f32 v8, v8, v142
    v_add_f32 v9, v9, v143
    v_cvt_pk_bf16_f32 v135, v142, v143
    s_waitcnt vmcnt(6)
    s_barrier
    ds_read_b128 v[160:163], v209 offset:17152
    s_waitcnt lgkmcnt(9)
    v_mfma_f32_32x32x16_bf16 v[96:111], v[168:171], v[128:131], v[96:111]
    v_exp_f32 v144, v144
    v_exp_f32 v145, v145
    ds_read_b128 v[164:167], v209 offset:17184
    v_mfma_f32_32x32x16_bf16 v[112:127], v[172:175], v[128:131], v[112:127]
    v_add_f32 v8, v8, v144
    v_add_f32 v9, v9, v145
    v_cvt_pk_bf16_f32 v144, v144, v145
    s_add_u32 s61, s75, 90112
    s_add_u32 m0, s49, 0
    s_and_b32 s61, s61, 0x1ffff
    buffer_load_dwordx4 v5, s[32:35], s61 offen offset:0 nt lds
    ds_read_b128 v[168:171], v209 offset:17216
    s_waitcnt lgkmcnt(7)
    v_mfma_f32_32x32x16_bf16 v[64:79], v[176:179], v[132:135], v[64:79]
    v_exp_f32 v146, v146
    v_exp_f32 v147, v147
    ds_read_b128 v[172:175], v209 offset:17248
    v_mfma_f32_32x32x16_bf16 v[80:95], v[180:183], v[132:135], v[80:95]
    v_add_f32 v8, v8, v146
    v_add_f32 v9, v9, v147
    v_cvt_pk_bf16_f32 v145, v146, v147
    ds_read_b128 v[176:179], v212 offset:17152
    s_waitcnt lgkmcnt(5)
    v_mfma_f32_32x32x16_bf16 v[96:111], v[184:187], v[132:135], v[96:111]
    v_exp_f32 v148, v148
    v_exp_f32 v149, v149
    ds_read_b128 v[180:183], v212 offset:17184
    v_mfma_f32_32x32x16_bf16 v[112:127], v[188:191], v[132:135], v[112:127]
    v_add_f32 v8, v8, v148
    v_add_f32 v9, v9, v149
    v_cvt_pk_bf16_f32 v146, v148, v149
    s_add_u32 m0, s49, 832
    s_nop 0
    buffer_load_dwordx4 v5, s[32:35], s61 offen offset:256 nt lds
    ds_read_b128 v[184:187], v212 offset:17216
    s_waitcnt lgkmcnt(5)
    v_mfma_f32_32x32x16_bf16 v[128:143], v[160:163], v[16:19], v[48:63]
    v_exp_f32 v150, v150
    v_exp_f32 v151, v151
    ds_read_b128 v[188:191], v212 offset:17248
    v_mfma_f32_32x32x16_bf16 v[128:143], v[164:167], v[20:23], v[128:143]
    v_add_f32 v8, v8, v150
    v_add_f32 v9, v9, v151
    v_cvt_pk_bf16_f32 v147, v150, v151
    ds_read_b64_tr_b16 v[160:161], v216 offset:0
    ds_read_b64_tr_b16 v[162:163], v216 offset:512
    s_waitcnt lgkmcnt(6)
    v_mfma_f32_32x32x16_bf16 v[128:143], v[168:171], v[24:27], v[128:143]
    v_exp_f32 v152, v152
    v_exp_f32 v153, v153
    ds_read_b64_tr_b16 v[164:165], v216 offset:64
    ds_read_b64_tr_b16 v[166:167], v216 offset:576
    v_mfma_f32_32x32x16_bf16 v[128:143], v[172:175], v[28:31], v[128:143]
    v_add_f32 v8, v8, v152
    v_add_f32 v9, v9, v153
    v_cvt_pk_bf16_f32 v148, v152, v153
    s_add_u32 s60, s75, 106496
    s_add_u32 m0, s48, 51456
    s_and_b32 s60, s60, 0x1ffff
    buffer_load_dwordx4 v4, s[28:31], s60 offen offset:0 nt lds
    ds_read_b64_tr_b16 v[168:169], v219 offset:0
    ds_read_b64_tr_b16 v[170:171], v219 offset:512
    s_waitcnt lgkmcnt(8)
    v_mfma_f32_32x32x16_bf16 v[128:143], v[176:179], v[32:35], v[128:143]
    v_exp_f32 v154, v154
    v_exp_f32 v155, v155
    ds_read_b64_tr_b16 v[172:173], v219 offset:64
    ds_read_b64_tr_b16 v[174:175], v219 offset:576
    v_mfma_f32_32x32x16_bf16 v[128:143], v[180:183], v[36:39], v[128:143]
    v_add_f32 v8, v8, v154
    v_add_f32 v9, v9, v155
    v_cvt_pk_bf16_f32 v149, v154, v155
    ds_read_b64_tr_b16 v[176:177], v216 offset:4288
    ds_read_b64_tr_b16 v[178:179], v216 offset:4800
    s_waitcnt lgkmcnt(10)
    v_mfma_f32_32x32x16_bf16 v[128:143], v[184:187], v[40:43], v[128:143]
    v_exp_f32 v156, v156
    v_exp_f32 v157, v157
    ds_read_b64_tr_b16 v[180:181], v216 offset:4352
    ds_read_b64_tr_b16 v[182:183], v216 offset:4864
    v_mfma_f32_32x32x16_bf16 v[128:143], v[188:191], v[44:47], v[128:143]
    v_add_f32 v8, v8, v156
    v_add_f32 v9, v9, v157
    v_cvt_pk_bf16_f32 v150, v156, v157
    s_add_u32 m0, s48, 52240
    s_nop 0
    buffer_load_dwordx4 v4, s[28:31], s60 offen offset:256 nt lds
    ds_read_b64_tr_b16 v[184:185], v219 offset:4288
    ds_read_b64_tr_b16 v[186:187], v219 offset:4800
    s_waitcnt lgkmcnt(10)
    v_mfma_f32_32x32x16_bf16 v[64:79], v[160:163], v[144:147], v[64:79]
    v_exp_f32 v158, v158
    v_exp_f32 v159, v159
    ds_read_b64_tr_b16 v[188:189], v219 offset:4352
    ds_read_b64_tr_b16 v[190:191], v219 offset:4864
    v_mfma_f32_32x32x16_bf16 v[80:95], v[164:167], v[144:147], v[80:95]
    v_add_f32 v8, v8, v158
    v_add_f32 v9, v9, v159
    v_cvt_pk_bf16_f32 v151, v158, v159
    s_waitcnt vmcnt(6)
    s_barrier
    ds_read_b128 v[160:163], v210 offset:17152
    s_waitcnt lgkmcnt(9)
    v_mfma_f32_32x32x16_bf16 v[96:111], v[168:171], v[144:147], v[96:111]
    v_exp_f32 v128, v128
    v_exp_f32 v129, v129
    ds_read_b128 v[164:167], v210 offset:17184
    v_mfma_f32_32x32x16_bf16 v[112:127], v[172:175], v[144:147], v[112:127]
    v_add_f32 v8, v8, v128
    v_add_f32 v9, v9, v129
    v_cvt_pk_bf16_f32 v128, v128, v129
    s_add_u32 s61, s70, 98304
    s_add_u32 m0, s49, 85760
    s_and_b32 s61, s61, 0x1ffff
    buffer_load_dwordx4 v5, s[32:35], s61 offen offset:0 nt lds
    ds_read_b128 v[168:171], v210 offset:17216
    s_waitcnt lgkmcnt(7)
    v_mfma_f32_32x32x16_bf16 v[64:79], v[176:179], v[148:151], v[64:79]
    v_exp_f32 v130, v130
    v_exp_f32 v131, v131
    ds_read_b128 v[172:175], v210 offset:17248
    v_mfma_f32_32x32x16_bf16 v[80:95], v[180:183], v[148:151], v[80:95]
    v_add_f32 v8, v8, v130
    v_add_f32 v9, v9, v131
    v_cvt_pk_bf16_f32 v129, v130, v131
    ds_read_b128 v[176:179], v213 offset:17152
    s_waitcnt lgkmcnt(5)
    v_mfma_f32_32x32x16_bf16 v[96:111], v[184:187], v[148:151], v[96:111]
    v_exp_f32 v132, v132
    v_exp_f32 v133, v133
    ds_read_b128 v[180:183], v213 offset:17184
    v_mfma_f32_32x32x16_bf16 v[112:127], v[188:191], v[148:151], v[112:127]
    v_add_f32 v8, v8, v132
    v_add_f32 v9, v9, v133
    v_cvt_pk_bf16_f32 v130, v132, v133
    s_add_u32 m0, s49, 86592
    s_nop 0
    buffer_load_dwordx4 v5, s[32:35], s61 offen offset:256 nt lds
    ds_read_b128 v[184:187], v213 offset:17216
    s_waitcnt lgkmcnt(5)
    v_mfma_f32_32x32x16_bf16 v[144:159], v[160:163], v[16:19], v[48:63]
    v_exp_f32 v134, v134
    v_exp_f32 v135, v135
    ds_read_b128 v[188:191], v213 offset:17248
    v_mfma_f32_32x32x16_bf16 v[144:159], v[164:167], v[20:23], v[144:159]
    v_add_f32 v8, v8, v134
    v_add_f32 v9, v9, v135
    v_cvt_pk_bf16_f32 v131, v134, v135
    ds_read_b64_tr_b16 v[160:161], v216 offset:34304
    ds_read_b64_tr_b16 v[162:163], v216 offset:34816
    s_waitcnt lgkmcnt(6)
    v_mfma_f32_32x32x16_bf16 v[144:159], v[168:171], v[24:27], v[144:159]
    v_exp_f32 v136, v136
    v_exp_f32 v137, v137
    ds_read_b64_tr_b16 v[164:165], v216 offset:34368
    ds_read_b64_tr_b16 v[166:167], v216 offset:34880
    v_mfma_f32_32x32x16_bf16 v[144:159], v[172:175], v[28:31], v[144:159]
    v_add_f32 v8, v8, v136
    v_add_f32 v9, v9, v137
    v_cvt_pk_bf16_f32 v132, v136, v137
    s_add_u32 s60, s70, 114688
    s_add_u32 m0, s48, 34304
    s_and_b32 s60, s60, 0x1ffff
    buffer_load_dwordx4 v4, s[28:31], s60 offen offset:0 nt lds
    ds_read_b64_tr_b16 v[168:169], v219 offset:34304
    ds_read_b64_tr_b16 v[170:171], v219 offset:34816
    s_waitcnt lgkmcnt(8)
    v_mfma_f32_32x32x16_bf16 v[144:159], v[176:179], v[32:35], v[144:159]
    v_exp_f32 v138, v138
    v_exp_f32 v139, v139
    ds_read_b64_tr_b16 v[172:173], v219 offset:34368
    ds_read_b64_tr_b16 v[174:175], v219 offset:34880
    v_mfma_f32_32x32x16_bf16 v[144:159], v[180:183], v[36:39], v[144:159]
    v_add_f32 v8, v8, v138
    v_add_f32 v9, v9, v139
    v_cvt_pk_bf16_f32 v133, v138, v139
    ds_read_b64_tr_b16 v[176:177], v216 offset:38592
    ds_read_b64_tr_b16 v[178:179], v216 offset:39104
    s_waitcnt lgkmcnt(10)
    v_mfma_f32_32x32x16_bf16 v[144:159], v[184:187], v[40:43], v[144:159]
    v_exp_f32 v140, v140
    v_exp_f32 v141, v141
    ds_read_b64_tr_b16 v[180:181], v216 offset:38656
    ds_read_b64_tr_b16 v[182:183], v216 offset:39168
    v_mfma_f32_32x32x16_bf16 v[144:159], v[188:191], v[44:47], v[144:159]
    v_add_f32 v8, v8, v140
    v_add_f32 v9, v9, v141
    v_cvt_pk_bf16_f32 v134, v140, v141
    s_add_u32 m0, s48, 35088
    s_nop 0
    buffer_load_dwordx4 v4, s[28:31], s60 offen offset:256 nt lds
    ds_read_b64_tr_b16 v[184:185], v219 offset:38592
    ds_read_b64_tr_b16 v[186:187], v219 offset:39104
    s_waitcnt lgkmcnt(10)
    v_mfma_f32_32x32x16_bf16 v[64:79], v[160:163], v[128:131], v[64:79]
    v_exp_f32 v142, v142
    v_exp_f32 v143, v143
    ds_read_b64_tr_b16 v[188:189], v219 offset:38656
    ds_read_b64_tr_b16 v[190:191], v219 offset:39168
    v_mfma_f32_32x32x16_bf16 v[80:95], v[164:167], v[128:131], v[80:95]
    v_add_f32 v8, v8, v142
    v_add_f32 v9, v9, v143
    v_cvt_pk_bf16_f32 v135, v142, v143
    s_waitcnt vmcnt(6)
    s_barrier
    ds_read_b128 v[160:163], v208 offset:17152
    s_waitcnt lgkmcnt(9)
    v_mfma_f32_32x32x16_bf16 v[96:111], v[168:171], v[128:131], v[96:111]
    v_exp_f32 v144, v144
    v_exp_f32 v145, v145
    ds_read_b128 v[164:167], v208 offset:17184
    v_mfma_f32_32x32x16_bf16 v[112:127], v[172:175], v[128:131], v[112:127]
    v_add_f32 v8, v8, v144
    v_add_f32 v9, v9, v145
    v_cvt_pk_bf16_f32 v144, v144, v145
    s_add_u32 s61, s75, 106496
    s_add_u32 m0, s49, 68608
    s_and_b32 s61, s61, 0x1ffff
    buffer_load_dwordx4 v5, s[32:35], s61 offen offset:0 nt lds
    ds_read_b128 v[168:171], v208 offset:17216
    s_waitcnt lgkmcnt(7)
    v_mfma_f32_32x32x16_bf16 v[64:79], v[176:179], v[132:135], v[64:79]
    v_exp_f32 v146, v146
    v_exp_f32 v147, v147
    ds_read_b128 v[172:175], v208 offset:17248
    v_mfma_f32_32x32x16_bf16 v[80:95], v[180:183], v[132:135], v[80:95]
    v_add_f32 v8, v8, v146
    v_add_f32 v9, v9, v147
    v_cvt_pk_bf16_f32 v145, v146, v147
    ds_read_b128 v[176:179], v211 offset:17152
    s_waitcnt lgkmcnt(5)
    v_mfma_f32_32x32x16_bf16 v[96:111], v[184:187], v[132:135], v[96:111]
    v_exp_f32 v148, v148
    v_exp_f32 v149, v149
    ds_read_b128 v[180:183], v211 offset:17184
    v_mfma_f32_32x32x16_bf16 v[112:127], v[188:191], v[132:135], v[112:127]
    v_add_f32 v8, v8, v148
    v_add_f32 v9, v9, v149
    v_cvt_pk_bf16_f32 v146, v148, v149
    s_add_u32 m0, s49, 69440
    s_nop 0
    buffer_load_dwordx4 v5, s[32:35], s61 offen offset:256 nt lds
    ds_read_b128 v[184:187], v211 offset:17216
    s_waitcnt lgkmcnt(5)
    v_mfma_f32_32x32x16_bf16 v[128:143], v[160:163], v[16:19], v[48:63]
    v_exp_f32 v150, v150
    v_exp_f32 v151, v151
    ds_read_b128 v[188:191], v211 offset:17248
    v_mfma_f32_32x32x16_bf16 v[128:143], v[164:167], v[20:23], v[128:143]
    v_add_f32 v8, v8, v150
    v_add_f32 v9, v9, v151
    v_cvt_pk_bf16_f32 v147, v150, v151
    ds_read_b64_tr_b16 v[160:161], v214 offset:0
    ds_read_b64_tr_b16 v[162:163], v214 offset:512
    s_waitcnt lgkmcnt(6)
    v_mfma_f32_32x32x16_bf16 v[128:143], v[168:171], v[24:27], v[128:143]
    v_exp_f32 v152, v152
    v_exp_f32 v153, v153
    ds_read_b64_tr_b16 v[164:165], v214 offset:64
    ds_read_b64_tr_b16 v[166:167], v214 offset:576
    v_mfma_f32_32x32x16_bf16 v[128:143], v[172:175], v[28:31], v[128:143]
    v_add_f32 v8, v8, v152
    v_add_f32 v9, v9, v153
    v_cvt_pk_bf16_f32 v148, v152, v153
    s_add_u32 s60, s75, 122880
    s_add_u32 m0, s48, 102912
    s_and_b32 s60, s60, 0x1ffff
    buffer_load_dwordx4 v4, s[28:31], s60 offen offset:0 nt lds
    ds_read_b64_tr_b16 v[168:169], v217 offset:0
    ds_read_b64_tr_b16 v[170:171], v217 offset:512
    s_waitcnt lgkmcnt(8)
    v_mfma_f32_32x32x16_bf16 v[128:143], v[176:179], v[32:35], v[128:143]
    v_exp_f32 v154, v154
    v_exp_f32 v155, v155
    ds_read_b64_tr_b16 v[172:173], v217 offset:64
    ds_read_b64_tr_b16 v[174:175], v217 offset:576
    v_mfma_f32_32x32x16_bf16 v[128:143], v[180:183], v[36:39], v[128:143]
    v_add_f32 v8, v8, v154
    v_add_f32 v9, v9, v155
    v_cvt_pk_bf16_f32 v149, v154, v155
    ds_read_b64_tr_b16 v[176:177], v214 offset:4288
    ds_read_b64_tr_b16 v[178:179], v214 offset:4800
    s_waitcnt lgkmcnt(10)
    v_mfma_f32_32x32x16_bf16 v[128:143], v[184:187], v[40:43], v[128:143]
    v_exp_f32 v156, v156
    v_exp_f32 v157, v157
    ds_read_b64_tr_b16 v[180:181], v214 offset:4352
    ds_read_b64_tr_b16 v[182:183], v214 offset:4864
    v_mfma_f32_32x32x16_bf16 v[128:143], v[188:191], v[44:47], v[128:143]
    v_add_f32 v8, v8, v156
    v_add_f32 v9, v9, v157
    v_cvt_pk_bf16_f32 v150, v156, v157
    s_add_u32 m0, s48, 103696
    s_nop 0
    buffer_load_dwordx4 v4, s[28:31], s60 offen offset:256 nt lds
    ds_read_b64_tr_b16 v[184:185], v217 offset:4288
    ds_read_b64_tr_b16 v[186:187], v217 offset:4800
    s_waitcnt lgkmcnt(10)
    v_mfma_f32_32x32x16_bf16 v[64:79], v[160:163], v[144:147], v[64:79]
    v_exp_f32 v158, v158
    v_exp_f32 v159, v159
    ds_read_b64_tr_b16 v[188:189], v217 offset:4352
    ds_read_b64_tr_b16 v[190:191], v217 offset:4864
    v_mfma_f32_32x32x16_bf16 v[80:95], v[164:167], v[144:147], v[80:95]
    v_add_f32 v8, v8, v158
    v_add_f32 v9, v9, v159
    v_cvt_pk_bf16_f32 v151, v158, v159
    s_waitcnt vmcnt(6)
    s_barrier
    ds_read_b128 v[160:163], v209 offset:0
    s_waitcnt lgkmcnt(9)
    v_mfma_f32_32x32x16_bf16 v[96:111], v[168:171], v[144:147], v[96:111]
    v_exp_f32 v128, v128
    v_exp_f32 v129, v129
    ds_read_b128 v[164:167], v209 offset:32
    v_mfma_f32_32x32x16_bf16 v[112:127], v[172:175], v[144:147], v[112:127]
    v_add_f32 v8, v8, v128
    v_add_f32 v9, v9, v129
    v_cvt_pk_bf16_f32 v128, v128, v129
    s_add_u32 s61, s70, 114688
    s_add_u32 m0, s49, 120064
    s_and_b32 s61, s61, 0x1ffff
    buffer_load_dwordx4 v5, s[32:35], s61 offen offset:0 nt lds
    ds_read_b128 v[168:171], v209 offset:64
    s_waitcnt lgkmcnt(7)
    v_mfma_f32_32x32x16_bf16 v[64:79], v[176:179], v[148:151], v[64:79]
    v_exp_f32 v130, v130
    v_exp_f32 v131, v131
    ds_read_b128 v[172:175], v209 offset:96
    v_mfma_f32_32x32x16_bf16 v[80:95], v[180:183], v[148:151], v[80:95]
    v_add_f32 v8, v8, v130
    v_add_f32 v9, v9, v131
    v_cvt_pk_bf16_f32 v129, v130, v131
    ds_read_b128 v[176:179], v212 offset:0
    s_waitcnt lgkmcnt(5)
    v_mfma_f32_32x32x16_bf16 v[96:111], v[184:187], v[148:151], v[96:111]
    v_exp_f32 v132, v132
    v_exp_f32 v133, v133
    ds_read_b128 v[180:183], v212 offset:32
    v_mfma_f32_32x32x16_bf16 v[112:127], v[188:191], v[148:151], v[112:127]
    v_add_f32 v8, v8, v132
    v_add_f32 v9, v9, v133
    v_cvt_pk_bf16_f32 v130, v132, v133
    s_add_u32 m0, s49, 120896
    s_nop 0
    buffer_load_dwordx4 v5, s[32:35], s61 offen offset:256 nt lds
    ds_read_b128 v[184:187], v212 offset:64
    s_waitcnt lgkmcnt(5)
    v_mfma_f32_32x32x16_bf16 v[144:159], v[160:163], v[16:19], v[48:63]
    v_exp_f32 v134, v134
    v_exp_f32 v135, v135
    ds_read_b128 v[188:191], v212 offset:96
    v_mfma_f32_32x32x16_bf16 v[144:159], v[164:167], v[20:23], v[144:159]
    v_add_f32 v8, v8, v134
    v_add_f32 v9, v9, v135
    v_cvt_pk_bf16_f32 v131, v134, v135
    ds_read_b64_tr_b16 v[160:161], v215 offset:34304
    ds_read_b64_tr_b16 v[162:163], v215 offset:34816
    s_waitcnt lgkmcnt(6)
    v_mfma_f32_32x32x16_bf16 v[144:159], v[168:171], v[24:27], v[144:159]
    v_exp_f32 v136, v136
    v_exp_f32 v137, v137
    ds_read_b64_tr_b16 v[164:165], v215 offset:34368
    ds_read_b64_tr_b16 v[166:167], v215 offset:34880
    v_mfma_f32_32x32x16_bf16 v[144:159], v[172:175], v[28:31], v[144:159]
    v_add_f32 v8, v8, v136
    v_add_f32 v9, v9, v137
    v_cvt_pk_bf16_f32 v132, v136, v137
    s_add_u32 s60, s75, 122880
    s_add_u32 m0, s49, 137216
    s_and_b32 s60, s60, 0x1ffff
    buffer_load_dwordx4 v5, s[32:35], s60 offen offset:0 nt lds
    ds_read_b64_tr_b16 v[168:169], v218 offset:34304
    ds_read_b64_tr_b16 v[170:171], v218 offset:34816
    s_waitcnt lgkmcnt(8)
    v_mfma_f32_32x32x16_bf16 v[144:159], v[176:179], v[32:35], v[144:159]
    v_exp_f32 v138, v138
    v_exp_f32 v139, v139
    ds_read_b64_tr_b16 v[172:173], v218 offset:34368
    ds_read_b64_tr_b16 v[174:175], v218 offset:34880
    v_mfma_f32_32x32x16_bf16 v[144:159], v[180:183], v[36:39], v[144:159]
    v_add_f32 v8, v8, v138
    v_add_f32 v9, v9, v139
    v_cvt_pk_bf16_f32 v133, v138, v139
    ds_read_b64_tr_b16 v[176:177], v215 offset:38592
    ds_read_b64_tr_b16 v[178:179], v215 offset:39104
    s_waitcnt lgkmcnt(10)
    v_mfma_f32_32x32x16_bf16 v[144:159], v[184:187], v[40:43], v[144:159]
    v_exp_f32 v140, v140
    v_exp_f32 v141, v141
    ds_read_b64_tr_b16 v[180:181], v215 offset:38656
    ds_read_b64_tr_b16 v[182:183], v215 offset:39168
    v_mfma_f32_32x32x16_bf16 v[144:159], v[188:191], v[44:47], v[144:159]
    v_add_f32 v8, v8, v140
    v_add_f32 v9, v9, v141
    v_cvt_pk_bf16_f32 v134, v140, v141
    s_add_u32 m0, s49, 138048
    s_nop 0
    buffer_load_dwordx4 v5, s[32:35], s60 offen offset:256 nt lds
    ds_read_b64_tr_b16 v[184:185], v218 offset:38592
    ds_read_b64_tr_b16 v[186:187], v218 offset:39104
    s_waitcnt lgkmcnt(10)
    v_mfma_f32_32x32x16_bf16 v[64:79], v[160:163], v[128:131], v[64:79]
    v_exp_f32 v142, v142
    v_exp_f32 v143, v143
    ds_read_b64_tr_b16 v[188:189], v218 offset:38656
    ds_read_b64_tr_b16 v[190:191], v218 offset:39168
    v_mfma_f32_32x32x16_bf16 v[80:95], v[164:167], v[128:131], v[80:95]
    v_add_f32 v8, v8, v142
    v_add_f32 v9, v9, v143
    v_cvt_pk_bf16_f32 v135, v142, v143
    s_waitcnt vmcnt(6)
    s_barrier
    ds_read_b128 v[160:163], v208 offset:34304
    s_waitcnt lgkmcnt(9)
    v_mfma_f32_32x32x16_bf16 v[96:111], v[168:171], v[128:131], v[96:111]
    v_exp_f32 v144, v144
    v_exp_f32 v145, v145
    ds_read_b128 v[164:167], v208 offset:34336
    v_mfma_f32_32x32x16_bf16 v[112:127], v[172:175], v[128:131], v[112:127]
    v_add_f32 v8, v8, v144
    v_add_f32 v9, v9, v145
    v_cvt_pk_bf16_f32 v192, v144, v145
    v_exp_f32 v146, v146
    v_exp_f32 v147, v147
    s_add_u32 s54, s76, 0
    s_add_u32 s61, s77, 0
    s_and_b32 s54, s54, 0x30000
    s_and_b32 s61, s61, 0x300
    s_add_u32 m0, s49, 17152
    s_or_b32 s61, s61, s54
    buffer_load_dwordx4 v6, s[36:39], s61 offen offset:0 lds
    ds_read_b128 v[168:171], v208 offset:34368
    s_waitcnt lgkmcnt(7)
    v_mfma_f32_32x32x16_bf16 v[64:79], v[176:179], v[132:135], v[64:79]
    v_add_f32 v8, v8, v146
    v_add_f32 v9, v9, v147
    v_cvt_pk_bf16_f32 v193, v146, v147
    ds_read_b128 v[172:175], v208 offset:34400
    v_mfma_f32_32x32x16_bf16 v[80:95], v[180:183], v[132:135], v[80:95]
    v_exp_f32 v148, v148
    v_exp_f32 v149, v149
    ds_read_b128 v[176:179], v211 offset:34304
    s_waitcnt lgkmcnt(5)
    v_mfma_f32_32x32x16_bf16 v[96:111], v[184:187], v[132:135], v[96:111]
    v_add_f32 v8, v8, v148
    v_add_f32 v9, v9, v149
    v_cvt_pk_bf16_f32 v194, v148, v149
    v_exp_f32 v150, v150
    v_exp_f32 v151, v151
    ds_read_b128 v[180:183], v211 offset:34336
    v_mfma_f32_32x32x16_bf16 v[112:127], v[188:191], v[132:135], v[112:127]
    v_add_f32 v8, v8, v150
    v_add_f32 v9, v9, v151
    v_cvt_pk_bf16_f32 v195, v150, v151
    s_add_u32 m0, s49, 17216
    s_nop 0
    buffer_load_dwordx4 v6, s[36:39], s61 offen offset:1024 lds
    ds_read_b128 v[184:187], v211 offset:34368
    s_waitcnt lgkmcnt(5)
    v_mfma_f32_32x32x16_bf16 v[128:143], v[160:163], v[16:19], v[48:63]
    v_exp_f32 v152, v152
    v_exp_f32 v153, v153
    ds_read_b128 v[188:191], v211 offset:34400
    v_mfma_f32_32x32x16_bf16 v[128:143], v[164:167], v[20:23], v[128:143]
    v_add_f32 v8, v8, v152
    v_add_f32 v9, v9, v153
    v_cvt_pk_bf16_f32 v196, v152, v153
    v_exp_f32 v154, v154
    v_exp_f32 v155, v155
    s_waitcnt vmcnt(4)
    s_barrier
    ds_read_b128 v[160:163], v210 offset:0
    s_waitcnt lgkmcnt(5)
    v_mfma_f32_32x32x16_bf16 v[128:143], v[168:171], v[24:27], v[128:143]
    v_add_f32 v8, v8, v154
    v_add_f32 v9, v9, v155
    v_cvt_pk_bf16_f32 v197, v154, v155
    ds_read_b128 v[164:167], v210 offset:32
    v_mfma_f32_32x32x16_bf16 v[128:143], v[172:175], v[28:31], v[128:143]
    v_exp_f32 v156, v156
    v_exp_f32 v157, v157
    s_add_u32 s54, s76, 65536
    s_add_u32 s60, s77, 0
    s_and_b32 s54, s54, 0x30000
    s_and_b32 s60, s60, 0x300
    s_add_u32 m0, s49, 51456
    s_or_b32 s60, s60, s54
    buffer_load_dwordx4 v6, s[36:39], s60 offen offset:0 lds
    ds_read_b128 v[168:171], v210 offset:64
    s_waitcnt lgkmcnt(5)
    v_mfma_f32_32x32x16_bf16 v[128:143], v[176:179], v[32:35], v[128:143]
    v_add_f32 v8, v8, v156
    v_add_f32 v9, v9, v157
    v_cvt_pk_bf16_f32 v198, v156, v157
    v_exp_f32 v158, v158
    v_exp_f32 v159, v159
    ds_read_b128 v[172:175], v210 offset:96
    v_mfma_f32_32x32x16_bf16 v[128:143], v[180:183], v[36:39], v[128:143]
    v_add_f32 v8, v8, v158
    v_add_f32 v9, v9, v159
    v_cvt_pk_bf16_f32 v199, v158, v159
    ds_read_b128 v[176:179], v213 offset:0
    s_waitcnt lgkmcnt(5)
    v_mfma_f32_32x32x16_bf16 v[128:143], v[184:187], v[40:43], v[128:143]
    ds_read_b128 v[180:183], v213 offset:32
    v_mfma_f32_32x32x16_bf16 v[128:143], v[188:191], v[44:47], v[128:143]
    s_add_u32 m0, s49, 51520
    s_nop 0
    buffer_load_dwordx4 v6, s[36:39], s60 offen offset:1024 lds
    ds_read_b128 v[184:187], v213 offset:64
    ds_read_b64_tr_b16 v[224:225], v215 offset:17152
    ds_read_b64_tr_b16 v[226:227], v215 offset:17664
    s_waitcnt lgkmcnt(7)
    v_mfma_f32_32x32x16_bf16 v[144:159], v[160:163], v[16:19], v[48:63]
    ds_read_b128 v[188:191], v213 offset:96
    ds_read_b64_tr_b16 v[228:229], v215 offset:21440
    ds_read_b64_tr_b16 v[230:231], v215 offset:21952
    v_mfma_f32_32x32x16_bf16 v[144:159], v[164:167], v[20:23], v[144:159]
    ds_read_b64_tr_b16 v[160:161], v218 offset:17152
    ds_read_b64_tr_b16 v[162:163], v218 offset:17664
    ds_read_b64_tr_b16 v[232:233], v215 offset:17216
    ds_read_b64_tr_b16 v[234:235], v215 offset:17728
    s_waitcnt lgkmcnt(12)
    v_mfma_f32_32x32x16_bf16 v[144:159], v[168:171], v[24:27], v[144:159]
    v_exp_f32 v128, v128
    v_exp_f32 v129, v129
    ds_read_b64_tr_b16 v[164:165], v218 offset:17216
    ds_read_b64_tr_b16 v[166:167], v218 offset:17728
    ds_read_b64_tr_b16 v[236:237], v215 offset:21504
    s_waitcnt lgkmcnt(14)
    ds_read_b64_tr_b16 v[238:239], v215 offset:22016
    v_mfma_f32_32x32x16_bf16 v[144:159], v[172:175], v[28:31], v[144:159]
    v_add_f32 v8, v8, v128
    v_add_f32 v9, v9, v129
    v_cvt_pk_bf16_f32 v128, v128, v129
    v_exp_f32 v130, v130
    v_exp_f32 v131, v131
    s_waitcnt lgkmcnt(14)
    ds_read_b64_tr_b16 v[168:169], v218 offset:21440
    s_waitcnt lgkmcnt(14)
    ds_read_b64_tr_b16 v[170:171], v218 offset:21952
    s_waitcnt lgkmcnt(14)
    ds_read_b64_tr_b16 v[240:241], v216 offset:17152
    s_waitcnt lgkmcnt(14)
    ds_read_b64_tr_b16 v[242:243], v216 offset:17664
    v_mfma_f32_32x32x16_bf16 v[144:159], v[176:179], v[32:35], v[144:159]
    v_add_f32 v8, v8, v130
    v_add_f32 v9, v9, v131
    v_cvt_pk_bf16_f32 v129, v130, v131
    v_exp_f32 v132, v132
    v_exp_f32 v133, v133
    s_waitcnt lgkmcnt(14)
    ds_read_b64_tr_b16 v[172:173], v218 offset:21504
    s_waitcnt lgkmcnt(14)
    ds_read_b64_tr_b16 v[174:175], v218 offset:22016
    s_waitcnt lgkmcnt(14)
    ds_read_b64_tr_b16 v[244:245], v216 offset:21440
    s_waitcnt lgkmcnt(14)
    ds_read_b64_tr_b16 v[246:247], v216 offset:21952
    v_mfma_f32_32x32x16_bf16 v[144:159], v[180:183], v[36:39], v[144:159]
    v_add_f32 v8, v8, v132
    v_add_f32 v9, v9, v133
    v_cvt_pk_bf16_f32 v130, v132, v133
    v_exp_f32 v134, v134
    v_exp_f32 v135, v135
    s_waitcnt lgkmcnt(14)
    ds_read_b64_tr_b16 v[176:177], v219 offset:17152
    s_waitcnt lgkmcnt(14)
    ds_read_b64_tr_b16 v[178:179], v219 offset:17664
    s_waitcnt lgkmcnt(14)
    ds_read_b64_tr_b16 v[248:249], v216 offset:17216
    s_waitcnt lgkmcnt(14)
    ds_read_b64_tr_b16 v[250:251], v216 offset:17728
    v_mfma_f32_32x32x16_bf16 v[144:159], v[184:187], v[40:43], v[144:159]
    v_add_f32 v8, v8, v134
    v_add_f32 v9, v9, v135
    v_cvt_pk_bf16_f32 v131, v134, v135
    v_exp_f32 v136, v136
    v_exp_f32 v137, v137
    s_waitcnt lgkmcnt(14)
    ds_read_b64_tr_b16 v[180:181], v219 offset:17216
    s_waitcnt lgkmcnt(14)
    ds_read_b64_tr_b16 v[182:183], v219 offset:17728
    s_waitcnt lgkmcnt(14)
    ds_read_b64_tr_b16 v[252:253], v216 offset:21504
    s_waitcnt lgkmcnt(14)
    ds_read_b64_tr_b16 v[254:255], v216 offset:22016
    v_mfma_f32_32x32x16_bf16 v[144:159], v[188:191], v[44:47], v[144:159]
    v_add_f32 v8, v8, v136
    v_add_f32 v9, v9, v137
    v_cvt_pk_bf16_f32 v132, v136, v137
    v_exp_f32 v138, v138
    v_exp_f32 v139, v139
    s_waitcnt lgkmcnt(14)
    ds_read_b64_tr_b16 v[184:185], v219 offset:21440
    s_waitcnt lgkmcnt(14)
    ds_read_b64_tr_b16 v[186:187], v219 offset:21952
    v_mfma_f32_32x32x16_bf16 v[96:111], v[160:163], v[192:195], v[96:111]
    v_add_f32 v8, v8, v138
    v_add_f32 v9, v9, v139
    v_cvt_pk_bf16_f32 v133, v138, v139
    v_exp_f32 v140, v140
    v_exp_f32 v141, v141
    s_waitcnt lgkmcnt(14)
    ds_read_b64_tr_b16 v[188:189], v219 offset:21504
    s_waitcnt lgkmcnt(14)
    ds_read_b64_tr_b16 v[190:191], v219 offset:22016
    v_mfma_f32_32x32x16_bf16 v[112:127], v[164:167], v[192:195], v[112:127]
    v_add_f32 v8, v8, v140
    v_add_f32 v9, v9, v141
    v_cvt_pk_bf16_f32 v134, v140, v141
    v_exp_f32 v142, v142
    v_exp_f32 v143, v143
    s_waitcnt vmcnt(4)
    s_barrier
    s_waitcnt lgkmcnt(14)
    ds_read_b64_tr_b16 v[160:161], v219 offset:34304
    s_waitcnt lgkmcnt(14)
    ds_read_b64_tr_b16 v[162:163], v219 offset:34816
    v_mfma_f32_32x32x16_bf16 v[96:111], v[168:171], v[196:199], v[96:111]
    v_add_f32 v8, v8, v142
    v_add_f32 v9, v9, v143
    v_cvt_pk_bf16_f32 v135, v142, v143
    s_waitcnt lgkmcnt(14)
    ds_read_b64_tr_b16 v[164:165], v219 offset:34368
    s_waitcnt lgkmcnt(14)
    ds_read_b64_tr_b16 v[166:167], v219 offset:34880
    v_mfma_f32_32x32x16_bf16 v[112:127], v[172:175], v[196:199], v[112:127]
    v_exp_f32 v144, v144
    v_exp_f32 v145, v145
    v_add_f32 v8, v8, v144
    v_add_f32 v9, v9, v145
    v_cvt_pk_bf16_f32 v144, v144, v145
    v_exp_f32 v146, v146
    v_exp_f32 v147, v147
    v_add_f32 v8, v8, v146
    v_add_f32 v9, v9, v147
    v_cvt_pk_bf16_f32 v145, v146, v147
    s_waitcnt lgkmcnt(14)
    ds_read_b64_tr_b16 v[168:169], v219 offset:38592
    s_waitcnt lgkmcnt(14)
    ds_read_b64_tr_b16 v[170:171], v219 offset:39104
    s_waitcnt lgkmcnt(12)
    v_mfma_f32_32x32x16_bf16 v[96:111], v[176:179], v[128:131], v[96:111]
    v_exp_f32 v148, v148
    v_exp_f32 v149, v149
    v_add_f32 v8, v8, v148
    v_add_f32 v9, v9, v149
    v_cvt_pk_bf16_f32 v146, v148, v149
    ds_read_b64_tr_b16 v[172:173], v219 offset:38656
    ds_read_b64_tr_b16 v[174:175], v219 offset:39168
    v_mfma_f32_32x32x16_bf16 v[112:127], v[180:183], v[128:131], v[112:127]
    v_exp_f32 v150, v150
    v_exp_f32 v151, v151
    v_add_f32 v8, v8, v150
    v_add_f32 v9, v9, v151
    v_cvt_pk_bf16_f32 v147, v150, v151
    ds_read_b64_tr_b16 v[176:177], v216 offset:34304
    s_waitcnt lgkmcnt(14)
    ds_read_b64_tr_b16 v[178:179], v216 offset:34816
    s_waitcnt lgkmcnt(10)
    v_mfma_f32_32x32x16_bf16 v[96:111], v[184:187], v[132:135], v[96:111]
    v_exp_f32 v152, v152
    v_exp_f32 v153, v153
    v_add_f32 v8, v8, v152
    v_add_f32 v9, v9, v153
    v_cvt_pk_bf16_f32 v148, v152, v153
    ds_read_b64_tr_b16 v[180:181], v216 offset:38592
    ds_read_b64_tr_b16 v[182:183], v216 offset:39104
    v_mfma_f32_32x32x16_bf16 v[112:127], v[188:191], v[132:135], v[112:127]
    v_exp_f32 v154, v154
    v_exp_f32 v155, v155
    v_add_f32 v8, v8, v154
    v_add_f32 v9, v9, v155
    v_cvt_pk_bf16_f32 v149, v154, v155
    ds_read_b64_tr_b16 v[184:185], v216 offset:34368
    ds_read_b64_tr_b16 v[186:187], v216 offset:34880
    s_waitcnt lgkmcnt(10)
    v_mfma_f32_32x32x16_bf16 v[96:111], v[160:163], v[144:147], v[96:111]
    v_exp_f32 v156, v156
    v_exp_f32 v157, v157
    v_add_f32 v8, v8, v156
    v_add_f32 v9, v9, v157
    v_cvt_pk_bf16_f32 v150, v156, v157
    ds_read_b64_tr_b16 v[188:189], v216 offset:38656
    ds_read_b64_tr_b16 v[190:191], v216 offset:39168
    v_mfma_f32_32x32x16_bf16 v[112:127], v[164:167], v[144:147], v[112:127]
    v_exp_f32 v158, v158
    v_exp_f32 v159, v159
    v_add_f32 v8, v8, v158
    v_add_f32 v9, v9, v159
    v_cvt_pk_bf16_f32 v151, v158, v159
    v_add_f32 v8, v8, v9
    s_mov_b32 s78, 0x49800000
    v_mov_b32 v9, v8
    s_waitcnt lgkmcnt(8)
    v_mfma_f32_32x32x16_bf16 v[96:111], v[168:171], v[148:151], v[96:111]
    v_permlane32_swap_b32 v8, v9
    v_add_f32 v8, v8, v9
    v_mov_b32 v9, v48
    v_cmp_nge_f32 vcc, s78, v8
    ds_write_b64 v200, v[8:9]
    v_mfma_f32_32x32x16_bf16 v[112:127], v[172:175], v[148:151], v[112:127]
    s_nop 1
    s_cbranch_vccz L_NOFLAG
    ds_write_b32 v202, v202
L_NOFLAG:
    s_waitcnt lgkmcnt(5)
    v_mfma_f32_32x32x16_bf16 v[64:79], v[176:179], v[144:147], v[64:79]
    s_nop 0
    ds_write_b128 v204, v[96:99] offset:0
    v_mfma_f32_32x32x16_bf16 v[64:79], v[180:183], v[148:151], v[64:79]
    ds_write_b128 v204, v[100:103] offset:1024
    ds_write_b128 v204, v[104:107] offset:2048
    s_waitcnt vmcnt(0)
    s_barrier
    s_waitcnt lgkmcnt(4)
    v_mfma_f32_32x32x16_bf16 v[80:95], v[184:187], v[144:147], v[80:95]
    ds_write_b128 v204, v[108:111] offset:3072
    s_add_u32 s54, s76, 131072
    s_add_u32 s61, s77, 0
    s_and_b32 s54, s54, 0x30000
    s_and_b32 s61, s61, 0x300
    s_add_u32 m0, s49, 68608
    s_or_b32 s61, s61, s54
    buffer_load_dwordx4 v6, s[36:39], s61 offen offset:0 lds
    v_mfma_f32_32x32x16_bf16 v[80:95], v[188:191], v[148:151], v[80:95]
    ds_write_b128 v204, v[112:115] offset:4096
    ds_read_b64_tr_b16 v[160:161], v220 offset:17152
    ds_read_b64_tr_b16 v[162:163], v220 offset:17408
    v_mfma_f32_32x32x16_bf16 v[64:79], v[224:227], v[192:195], v[64:79]
    ds_write_b128 v204, v[116:119] offset:5120
    ds_read_b64_tr_b16 v[164:165], v220 offset:21440
    ds_read_b64_tr_b16 v[166:167], v220 offset:21696
    v_mfma_f32_32x32x16_bf16 v[64:79], v[228:231], v[196:199], v[64:79]
    ds_write_b128 v204, v[120:123] offset:6144
    ds_read_b64_tr_b16 v[168:169], v220 offset:25728
    ds_read_b64_tr_b16 v[170:171], v220 offset:25984
    v_mfma_f32_32x32x16_bf16 v[80:95], v[232:235], v[192:195], v[80:95]
    ds_write_b128 v204, v[124:127] offset:7168
    s_add_u32 m0, s49, 68672
    s_nop 0
    buffer_load_dwordx4 v6, s[36:39], s61 offen offset:1024 lds
    s_waitcnt lgkmcnt(14)
    ds_read_b64_tr_b16 v[172:173], v220 offset:30016
    s_waitcnt lgkmcnt(14)
    ds_read_b64_tr_b16 v[174:175], v220 offset:30272
    v_mfma_f32_32x32x16_bf16 v[80:95], v[236:239], v[196:199], v[80:95]
    s_waitcnt lgkmcnt(14)
    ds_read_b64_tr_b16 v[176:177], v221 offset:0
    s_waitcnt lgkmcnt(14)
    ds_read_b64_tr_b16 v[178:179], v221 offset:256
    v_mfma_f32_32x32x16_bf16 v[64:79], v[240:243], v[128:131], v[64:79]
    s_waitcnt lgkmcnt(4)
    s_barrier
    ds_read_b32 v11, v202
    ds_read_b64 v[12:13], v201
    ds_read_b128 v[48:51], v203 offset:0
    ds_read_b128 v[52:55], v203 offset:1024
    ds_read_b128 v[56:59], v203 offset:2048
    ds_read_b128 v[60:63], v203 offset:3072
    ds_read_b128 v[136:139], v203 offset:4096
    ds_read_b128 v[140:143], v203 offset:5120
    ds_read_b128 v[152:155], v203 offset:6144
    ds_read_b128 v[156:159], v203 offset:7168
    ds_read_b64_tr_b16 v[180:181], v221 offset:4288
    s_waitcnt lgkmcnt(14)
    ds_read_b64_tr_b16 v[182:183], v221 offset:4544
    v_mfma_f32_32x32x16_bf16 v[64:79], v[244:247], v[132:135], v[64:79]
    s_waitcnt lgkmcnt(11)
    v_cmp_ne_u32 vcc, 0, v11
    s_waitcnt lgkmcnt(10)
    v_min_f32 v10, v9, v13
    v_sub_f32 v14, v10, v9
    v_sub_f32 v15, v10, v13
    v_exp_f32 v14, v14
    v_exp_f32 v15, v15
    s_andn2_b64 vcc, vcc, s[52:53]
    s_cbranch_scc1 L_FALLBACK
    v_mul_f32 v10, v8, v14
    v_fmac_f32 v10, v12, v15
    v_rcp_f32 v10, v10
    s_nop 0
    v_mul_f32 v14, v14, v10
    v_mul_f32 v15, v15, v10
    ds_read_b64_tr_b16 v[184:185], v221 offset:8576
    ds_read_b64_tr_b16 v[186:187], v221 offset:8832
    v_mfma_f32_32x32x16_bf16 v[80:95], v[248:251], v[128:131], v[80:95]
    s_waitcnt lgkmcnt(11)
    v_mul_f32 v48, v48, v15
    v_mul_f32 v49, v49, v15
    v_mul_f32 v50, v50, v15
    v_mul_f32 v51, v51, v15
    s_waitcnt lgkmcnt(10)
    v_mul_f32 v52, v52, v15
    v_mul_f32 v53, v53, v15
    v_mul_f32 v54, v54, v15
    v_mul_f32 v55, v55, v15
    s_waitcnt lgkmcnt(9)
    v_mul_f32 v56, v56, v15
    v_mul_f32 v57, v57, v15
    v_mul_f32 v58, v58, v15
    v_mul_f32 v59, v59, v15
    s_waitcnt lgkmcnt(8)
    v_mul_f32 v60, v60, v15
    v_mul_f32 v61, v61, v15
    v_mul_f32 v62, v62, v15
    v_mul_f32 v63, v63, v15
    s_add_u32 s54, s76, 196608
    s_add_u32 s60, s77, 0
    s_and_b32 s54, s54, 0x30000
    s_and_b32 s60, s60, 0x300
    s_add_u32 m0, s49, 120064
    s_or_b32 s60, s60, s54
    buffer_load_dwordx4 v6, s[36:39], s60 offen offset:0 lds
    ds_read_b64_tr_b16 v[188:189], v221 offset:12864
    ds_read_b64_tr_b16 v[190:191], v221 offset:13120
    v_mfma_f32_32x32x16_bf16 v[80:95], v[252:255], v[132:135], v[80:95]
    s_waitcnt lgkmcnt(9)
    v_mul_f32 v136, v136, v15
    v_mul_f32 v137, v137, v15
    v_mul_f32 v138, v138, v15
    v_mul_f32 v139, v139, v15
    s_waitcnt lgkmcnt(8)
    v_mul_f32 v140, v140, v15
    v_mul_f32 v141, v141, v15
    v_mul_f32 v142, v142, v15
    v_mul_f32 v143, v143, v15
    s_waitcnt lgkmcnt(7)
    v_mul_f32 v152, v152, v15
    v_mul_f32 v153, v153, v15
    v_mul_f32 v154, v154, v15
    v_mul_f32 v155, v155, v15
    s_waitcnt lgkmcnt(6)
    v_mul_f32 v156, v156, v15
    v_mul_f32 v157, v157, v15
    v_mul_f32 v158, v158, v15
    v_mul_f32 v159, v159, v15
    v_fmac_f32 v48, v64, v14
    v_fmac_f32 v49, v65, v14
    v_fmac_f32 v50, v66, v14
    v_fmac_f32 v51, v67, v14
    v_fmac_f32 v52, v68, v14
    v_fmac_f32 v53, v69, v14
    v_fmac_f32 v54, v70, v14
    v_fmac_f32 v55, v71, v14
    v_cvt_pk_bf16_f32 v96, v48, v49
    v_cvt_pk_bf16_f32 v97, v50, v51
    v_cvt_pk_bf16_f32 v98, v52, v53
    v_cvt_pk_bf16_f32 v99, v54, v55
    ds_write_b128 v203, v[96:99] offset:0
    v_fmac_f32 v56, v72, v14
    v_fmac_f32 v57, v73, v14
    v_fmac_f32 v58, v74, v14
    v_fmac_f32 v59, v75, v14
    v_fmac_f32 v60, v76, v14
    v_fmac_f32 v61, v77, v14
    v_fmac_f32 v62, v78, v14
    v_fmac_f32 v63, v79, v14
    v_cvt_pk_bf16_f32 v100, v56, v57
    v_cvt_pk_bf16_f32 v101, v58, v59
    v_cvt_pk_bf16_f32 v102, v60, v61
    v_cvt_pk_bf16_f32 v103, v62, v63
    ds_write_b128 v203, v[100:103] offset:1024
    s_add_u32 m0, s49, 120128
    s_nop 0
    buffer_load_dwordx4 v6, s[36:39], s60 offen offset:1024 lds
    s_add_u32 s54, s76, 0
    s_add_u32 s61, s77, 256
    s_and_b32 s54, s54, 0x30000
    s_and_b32 s61, s61, 0x300
    s_add_u32 m0, s49, 137216
    s_or_b32 s61, s61, s54
    buffer_load_dwordx4 v6, s[36:39], s61 offen offset:0 lds
    v_fmac_f32 v136, v80, v14
    v_fmac_f32 v137, v81, v14
    v_fmac_f32 v138, v82, v14
    v_fmac_f32 v139, v83, v14
    v_fmac_f32 v140, v84, v14
    v_fmac_f32 v141, v85, v14
    v_fmac_f32 v142, v86, v14
    v_fmac_f32 v143, v87, v14
    v_cvt_pk_bf16_f32 v104, v136, v137
    v_cvt_pk_bf16_f32 v105, v138, v139
    v_cvt_pk_bf16_f32 v106, v140, v141
    v_cvt_pk_bf16_f32 v107, v142, v143
    ds_write_b128 v203, v[104:107] offset:2048
    v_fmac_f32 v152, v88, v14
    v_fmac_f32 v153, v89, v14
    v_fmac_f32 v154, v90, v14
    v_fmac_f32 v155, v91, v14
    v_fmac_f32 v156, v92, v14
    v_fmac_f32 v157, v93, v14
    v_fmac_f32 v158, v94, v14
    v_fmac_f32 v159, v95, v14
    v_cvt_pk_bf16_f32 v108, v152, v153
    v_cvt_pk_bf16_f32 v109, v154, v155
    v_cvt_pk_bf16_f32 v110, v156, v157
    v_cvt_pk_bf16_f32 v111, v158, v159
    ds_write_b128 v203, v[108:111] offset:3072
    s_add_u32 m0, s49, 137280
    s_nop 0
    buffer_load_dwordx4 v6, s[36:39], s61 offen offset:1024 lds
    s_waitcnt lgkmcnt(0)
    s_waitcnt vmcnt(4)
    s_barrier
    s_add_u32 s54, s76, 65536
    s_add_u32 s60, s77, 256
    s_and_b32 s54, s54, 0x30000
    s_and_b32 s60, s60, 0x300
    s_add_u32 m0, s49, 17152
    s_or_b32 s60, s60, s54
    buffer_load_dwordx4 v6, s[36:39], s60 offen offset:0 lds
    s_add_u32 m0, s49, 17216
    s_nop 0
    buffer_load_dwordx4 v6, s[36:39], s60 offen offset:1024 lds
    ds_read_b128 v[16:19], v205 offset:0
    ds_read_b128 v[20:23], v205 offset:1024
    ds_read_b128 v[24:27], v205 offset:2048
    ds_read_b128 v[28:31], v205 offset:3072
    s_waitcnt lgkmcnt(3)
    v_mfma_f32_32x32x16_bf16 v[64:79], v[160:163], v[16:19], 0
    ds_read_b128 v[32:35], v206 offset:0
    ds_read_b128 v[36:39], v206 offset:1024
    s_waitcnt lgkmcnt(4)
    v_mfma_f32_32x32x16_bf16 v[64:79], v[164:167], v[20:23], v[64:79]
    ds_read_b128 v[40:43], v206 offset:2048
    ds_read_b128 v[44:47], v206 offset:3072
    s_add_u32 s54, s76, 131072
    s_add_u32 s61, s77, 256
    s_and_b32 s54, s54, 0x30000
    s_and_b32 s61, s61, 0x300
    s_add_u32 m0, s49, 51456
    s_or_b32 s61, s61, s54
    buffer_load_dwordx4 v6, s[36:39], s61 offen offset:0 lds
    s_waitcnt lgkmcnt(5)
    v_mfma_f32_32x32x16_bf16 v[64:79], v[168:171], v[24:27], v[64:79]
    ds_read_b128 v[224:227], v207 offset:0
    ds_read_b128 v[228:231], v207 offset:1024
    s_waitcnt lgkmcnt(6)
    v_mfma_f32_32x32x16_bf16 v[64:79], v[172:175], v[28:31], v[64:79]
    ds_read_b128 v[232:235], v207 offset:2048
    ds_read_b128 v[236:239], v207 offset:3072
    s_add_u32 m0, s49, 51520
    s_nop 0
    buffer_load_dwordx4 v6, s[36:39], s61 offen offset:1024 lds
    s_waitcnt lgkmcnt(7)
    v_mfma_f32_32x32x16_bf16 v[64:79], v[176:179], v[32:35], v[64:79]
    ds_read_b128 v[240:243], v223 offset:0
    ds_read_b128 v[244:247], v223 offset:1024
    ds_read_b64_tr_b16 v[160:161], v221 offset:17152
    ds_read_b64_tr_b16 v[162:163], v221 offset:17408
    s_waitcnt lgkmcnt(10)
    v_mfma_f32_32x32x16_bf16 v[64:79], v[180:183], v[36:39], v[64:79]
    ds_read_b128 v[248:251], v223 offset:2048
    ds_read_b128 v[252:255], v223 offset:3072
    ds_read_b64_tr_b16 v[164:165], v221 offset:21440
    ds_read_b64_tr_b16 v[166:167], v221 offset:21696
    s_waitcnt lgkmcnt(13)
    v_mfma_f32_32x32x16_bf16 v[64:79], v[184:187], v[40:43], v[64:79]
    ds_read_b64_tr_b16 v[168:169], v221 offset:25728
    ds_read_b64_tr_b16 v[170:171], v221 offset:25984
    s_waitcnt lgkmcnt(14)
    v_mfma_f32_32x32x16_bf16 v[64:79], v[188:191], v[44:47], v[64:79]
    s_waitcnt vmcnt(6)
    s_barrier
    ds_read_b64_tr_b16 v[172:173], v221 offset:30016
    s_waitcnt lgkmcnt(14)
    ds_read_b64_tr_b16 v[174:175], v221 offset:30272
    s_waitcnt lgkmcnt(8)
    v_mfma_f32_32x32x16_bf16 v[64:79], v[160:163], v[224:227], v[64:79]
    ds_read_b64_tr_b16 v[176:177], v222 offset:17152
    ds_read_b64_tr_b16 v[178:179], v222 offset:17408
    s_waitcnt lgkmcnt(6)
    v_mfma_f32_32x32x16_bf16 v[64:79], v[164:167], v[228:231], v[64:79]
    ds_read_b64_tr_b16 v[180:181], v222 offset:21440
    ds_read_b64_tr_b16 v[182:183], v222 offset:21696
    s_waitcnt lgkmcnt(6)
    v_mfma_f32_32x32x16_bf16 v[64:79], v[168:171], v[232:235], v[64:79]
    ds_read_b64_tr_b16 v[184:185], v222 offset:25728
    ds_read_b64_tr_b16 v[186:187], v222 offset:25984
    s_waitcnt lgkmcnt(6)
    v_mfma_f32_32x32x16_bf16 v[64:79], v[172:175], v[236:239], v[64:79]
    s_waitcnt vmcnt(4)
    s_barrier
    s_add_u32 s54, s76, 196608
    s_add_u32 s60, s77, 256
    s_and_b32 s54, s54, 0x30000
    s_and_b32 s60, s60, 0x300
    s_add_u32 m0, s49, 68608
    s_or_b32 s60, s60, s54
    buffer_load_dwordx4 v6, s[36:39], s60 offen offset:0 lds
    s_add_u32 m0, s49, 68672
    s_nop 0
    buffer_load_dwordx4 v6, s[36:39], s60 offen offset:1024 lds
    ds_read_b64_tr_b16 v[188:189], v222 offset:30016
    ds_read_b64_tr_b16 v[190:191], v222 offset:30272
    s_waitcnt lgkmcnt(6)
    v_mfma_f32_32x32x16_bf16 v[64:79], v[176:179], v[240:243], v[64:79]
    ds_read_b64_tr_b16 v[160:161], v222 offset:34304
    ds_read_b64_tr_b16 v[162:163], v222 offset:34560
    s_waitcnt lgkmcnt(6)
    v_mfma_f32_32x32x16_bf16 v[64:79], v[180:183], v[244:247], v[64:79]
    s_add_u32 s54, s76, 0
    s_add_u32 s61, s77, 512
    s_and_b32 s54, s54, 0x30000
    s_and_b32 s61, s61, 0x300
    s_add_u32 m0, s49, 0
    s_or_b32 s61, s61, s54
    buffer_load_dwordx4 v6, s[36:39], s61 offen offset:0 lds
    ds_read_b64_tr_b16 v[164:165], v222 offset:38592
    ds_read_b64_tr_b16 v[166:167], v222 offset:38848
    s_waitcnt lgkmcnt(6)
    v_mfma_f32_32x32x16_bf16 v[64:79], v[184:187], v[248:251], v[64:79]
    ds_read_b64_tr_b16 v[168:169], v222 offset:42880
    ds_read_b64_tr_b16 v[170:171], v222 offset:43136
    s_waitcnt lgkmcnt(6)
    v_mfma_f32_32x32x16_bf16 v[64:79], v[188:191], v[252:255], v[64:79]
    s_add_u32 m0, s49, 64
    s_nop 0
    buffer_load_dwordx4 v6, s[36:39], s61 offen offset:1024 lds
    s_waitcnt vmcnt(6)
    s_barrier
    ds_read_b64_tr_b16 v[172:173], v222 offset:47168
    ds_read_b64_tr_b16 v[174:175], v222 offset:47424
    s_waitcnt lgkmcnt(6)
    v_mfma_f32_32x32x16_bf16 v[80:95], v[160:163], v[16:19], 0
    ds_read_b64_tr_b16 v[176:177], v220 offset:17152
    ds_read_b64_tr_b16 v[178:179], v220 offset:17408
    s_waitcnt lgkmcnt(6)
    v_mfma_f32_32x32x16_bf16 v[80:95], v[164:167], v[20:23], v[80:95]
    s_add_u32 s54, s76, 65536
    s_add_u32 s60, s77, 512
    s_and_b32 s54, s54, 0x30000
    s_and_b32 s60, s60, 0x300
    s_add_u32 m0, s49, 85760
    s_or_b32 s60, s60, s54
    buffer_load_dwordx4 v6, s[36:39], s60 offen offset:0 lds
    ds_read_b64_tr_b16 v[180:181], v220 offset:21440
    ds_read_b64_tr_b16 v[182:183], v220 offset:21696
    s_waitcnt lgkmcnt(6)
    v_mfma_f32_32x32x16_bf16 v[80:95], v[168:171], v[24:27], v[80:95]
    v_lshlrev_b32 v10, 11, v1
    v_mov_b32 v11, 0x5ca1ab1e
    s_add_u32 s55, s77, 0
    s_and_b32 s55, s55, 0x300
    s_lshl_b32 s55, s55, 6
    s_lshl_b32 s56, s44, 11
    s_add_u32 s57, s55, s56
    v_cvt_pk_bf16_f32 v128, v64, v65
    v_cvt_pk_bf16_f32 v129, v66, v67
    v_cvt_pk_bf16_f32 v130, v68, v69
    v_cvt_pk_bf16_f32 v131, v70, v71
    buffer_store_dwordx4 v[128:131], v7, s[40:43], s57 offen offset:0 sc1
    ds_read_b64_tr_b16 v[184:185], v220 offset:25728
    ds_read_b64_tr_b16 v[186:187], v220 offset:25984
    s_waitcnt lgkmcnt(6)
    v_mfma_f32_32x32x16_bf16 v[80:95], v[172:175], v[28:31], v[80:95]
    v_cvt_pk_bf16_f32 v132, v72, v73
    v_cvt_pk_bf16_f32 v133, v74, v75
    v_cvt_pk_bf16_f32 v134, v76, v77
    v_cvt_pk_bf16_f32 v135, v78, v79
    buffer_store_dwordx4 v[132:135], v7, s[40:43], s57 offen offset:1024 sc1
    s_add_u32 m0, s49, 85824
    s_nop 0
    buffer_load_dwordx4 v6, s[36:39], s60 offen offset:1024 lds
    s_waitcnt vmcnt(8)
    s_barrier
    ds_read_b64_tr_b16 v[188:189], v220 offset:30016
    ds_read_b64_tr_b16 v[190:191], v220 offset:30272
    s_waitcnt lgkmcnt(6)
    v_mfma_f32_32x32x16_bf16 v[80:95], v[176:179], v[32:35], v[80:95]
    ds_read_b64_tr_b16 v[160:161], v221 offset:0
    ds_read_b64_tr_b16 v[162:163], v221 offset:256
    s_waitcnt lgkmcnt(6)
    v_mfma_f32_32x32x16_bf16 v[80:95], v[180:183], v[36:39], v[80:95]
    s_add_u32 s54, s76, 131072
    s_add_u32 s61, s77, 512
    s_and_b32 s54, s54, 0x30000
    s_and_b32 s61, s61, 0x300
    s_add_u32 m0, s49, 34304
    s_or_b32 s61, s61, s54
    buffer_load_dwordx4 v6, s[36:39], s61 offen offset:0 lds
    ds_read_b64_tr_b16 v[164:165], v221 offset:4288
    ds_read_b64_tr_b16 v[166:167], v221 offset:4544
    s_waitcnt lgkmcnt(6)
    v_mfma_f32_32x32x16_bf16 v[80:95], v[184:187], v[40:43], v[80:95]
    ds_read_b64_tr_b16 v[168:169], v221 offset:8576
    ds_read_b64_tr_b16 v[170:171], v221 offset:8832
    s_waitcnt lgkmcnt(6)
    v_mfma_f32_32x32x16_bf16 v[80:95], v[188:191], v[44:47], v[80:95]
    s_add_u32 m0, s49, 34368
    s_nop 0
    buffer_load_dwordx4 v6, s[36:39], s61 offen offset:1024 lds
    s_waitcnt vmcnt(8)
    s_barrier
    ds_read_b64_tr_b16 v[172:173], v221 offset:12864
    ds_read_b64_tr_b16 v[174:175], v221 offset:13120
    s_waitcnt lgkmcnt(6)
    v_mfma_f32_32x32x16_bf16 v[80:95], v[160:163], v[224:227], v[80:95]
    s_and_b32 s57, s44, 3
    s_lshl_b32 s81, s57, 8
    s_add_u32 s81, s81, s77
    s_and_b32 s81, s81, 0x300
    s_lshl_b32 s55, s81, 6
    s_lshl_b32 s56, s79, 10
    s_add_u32 s55, s55, s56
    v_add_u32 v13, s55, v7
    s_lshr_b32 s56, s79, 1
    s_lshl_b32 s82, s56, 6
    s_lshl_b32 s55, s57, 9
    s_add_u32 s82, s82, s55
    v_and_b32 v14, 15, v1
    v_lshlrev_b32 v14, 2, v14
    ds_read_b64_tr_b16 v[176:177], v221 offset:17152
    ds_read_b64_tr_b16 v[178:179], v221 offset:17408
    s_waitcnt lgkmcnt(6)
    v_mfma_f32_32x32x16_bf16 v[80:95], v[164:167], v[228:231], v[80:95]
    s_lshr_b32 s56, s79, 1
    v_and_b32 v15, 31, v1
    v_lshlrev_b32 v15, 10, v15
    v_lshrrev_b32 v8, 5, v1
    v_lshl_add_u32 v15, v8, 4, v15
    s_and_b32 s55, s56, 1
    s_lshl_b32 s55, s55, 15
    s_add_u32 s81, s81, s55
    s_lshr_b32 s55, s56, 1
    s_lshl_b32 s55, s55, 6
    s_add_u32 s81, s81, s55
    s_and_b32 s55, s79, 1
    s_lshl_b32 s55, s55, 5
    s_add_u32 s81, s81, s55
    s_add_u32 s54, s76, 196608
    s_add_u32 s60, s77, 512
    s_and_b32 s54, s54, 0x30000
    s_and_b32 s60, s60, 0x300
    s_add_u32 m0, s49, 102912
    s_or_b32 s60, s60, s54
    buffer_load_dwordx4 v6, s[36:39], s60 offen offset:0 lds
    ds_read_b64_tr_b16 v[180:181], v221 offset:21440
    ds_read_b64_tr_b16 v[182:183], v221 offset:21696
    s_waitcnt lgkmcnt(6)
    v_mfma_f32_32x32x16_bf16 v[80:95], v[168:171], v[232:235], v[80:95]
    s_mov_b32 s4, 0
    s_mov_b32 s5, 65536
    s_mov_b32 s6, 131072
    s_mov_b32 s7, 196608
    s_mov_b32 s8, 262144
    s_mov_b32 s9, 327680
    s_mov_b32 s10, 393216
    s_mov_b32 s11, 458752
    s_mov_b32 s12, 524288
    s_mov_b32 s13, 589824
    s_mov_b32 s14, 655360
    s_mov_b32 s15, 720896
    s_mov_b32 s16, 786432
    s_mov_b32 s17, 851968
    s_mov_b32 s18, 917504
    s_mov_b32 s19, 983040
    ds_read_b64_tr_b16 v[184:185], v221 offset:25728
    ds_read_b64_tr_b16 v[186:187], v221 offset:25984
    s_waitcnt lgkmcnt(6)
    v_mfma_f32_32x32x16_bf16 v[80:95], v[172:175], v[236:239], v[80:95]
    s_add_u32 m0, s49, 102976
    s_nop 0
    buffer_load_dwordx4 v6, s[36:39], s60 offen offset:1024 lds
    s_waitcnt vmcnt(8)
    s_barrier
    ds_read_b64_tr_b16 v[188:189], v221 offset:30016
    ds_read_b64_tr_b16 v[190:191], v221 offset:30272
    s_waitcnt lgkmcnt(6)
    v_mfma_f32_32x32x16_bf16 v[80:95], v[176:179], v[240:243], v[80:95]
    ds_read_b64_tr_b16 v[160:161], v220 offset:0
    ds_read_b64_tr_b16 v[162:163], v220 offset:256
    s_waitcnt lgkmcnt(6)
    v_mfma_f32_32x32x16_bf16 v[80:95], v[180:183], v[244:247], v[80:95]
    s_add_u32 s54, s76, 0
    s_add_u32 s61, s77, 768
    s_and_b32 s54, s54, 0x30000
    s_and_b32 s61, s61, 0x300
    s_add_u32 m0, s49, 120064
    s_or_b32 s61, s61, s54
    buffer_load_dwordx4 v6, s[36:39], s61 offen offset:0 lds
    ds_read_b64_tr_b16 v[164:165], v220 offset:4288
    ds_read_b64_tr_b16 v[166:167], v220 offset:4544
    s_waitcnt lgkmcnt(6)
    v_mfma_f32_32x32x16_bf16 v[80:95], v[184:187], v[248:251], v[80:95]
    ds_read_b64_tr_b16 v[168:169], v220 offset:8576
    ds_read_b64_tr_b16 v[170:171], v220 offset:8832
    s_waitcnt lgkmcnt(6)
    v_mfma_f32_32x32x16_bf16 v[80:95], v[188:191], v[252:255], v[80:95]
    s_add_u32 m0, s49, 120128
    s_nop 0
    buffer_load_dwordx4 v6, s[36:39], s61 offen offset:1024 lds
    s_waitcnt vmcnt(6)
    s_barrier
    ds_read_b64_tr_b16 v[172:173], v220 offset:12864
    ds_read_b64_tr_b16 v[174:175], v220 offset:13120
    s_waitcnt lgkmcnt(6)
    v_mfma_f32_32x32x16_bf16 v[96:111], v[160:163], v[16:19], 0
    buffer_store_dword v11, v10, s[84:87], s51 offen offset:0 sc1
    ds_read_b64_tr_b16 v[176:177], v221 offset:34304
    ds_read_b64_tr_b16 v[178:179], v221 offset:34560
    s_waitcnt lgkmcnt(6)
    v_mfma_f32_32x32x16_bf16 v[96:111], v[164:167], v[20:23], v[96:111]
    s_add_u32 s54, s76, 65536
    s_add_u32 s60, s77, 768
    s_and_b32 s54, s54, 0x30000
    s_and_b32 s60, s60, 0x300
    s_add_u32 m0, s49, 137216
    s_or_b32 s60, s60, s54
    buffer_load_dwordx4 v6, s[36:39], s60 offen offset:0 lds
    ds_read_b64_tr_b16 v[180:181], v221 offset:38592
    ds_read_b64_tr_b16 v[182:183], v221 offset:38848
    s_waitcnt lgkmcnt(6)
    v_mfma_f32_32x32x16_bf16 v[96:111], v[168:171], v[24:27], v[96:111]
    s_add_u32 s55, s77, 256
    s_and_b32 s55, s55, 0x300
    s_lshl_b32 s55, s55, 6
    s_lshl_b32 s56, s44, 11
    s_add_u32 s57, s55, s56
    v_cvt_pk_bf16_f32 v136, v80, v81
    v_cvt_pk_bf16_f32 v137, v82, v83
    v_cvt_pk_bf16_f32 v138, v84, v85
    v_cvt_pk_bf16_f32 v139, v86, v87
    buffer_store_dwordx4 v[136:139], v7, s[40:43], s57 offen offset:0 sc1
    ds_read_b64_tr_b16 v[184:185], v221 offset:42880
    ds_read_b64_tr_b16 v[186:187], v221 offset:43136
    s_waitcnt lgkmcnt(6)
    v_mfma_f32_32x32x16_bf16 v[96:111], v[172:175], v[28:31], v[96:111]
    v_cvt_pk_bf16_f32 v140, v88, v89
    v_cvt_pk_bf16_f32 v141, v90, v91
    v_cvt_pk_bf16_f32 v142, v92, v93
    v_cvt_pk_bf16_f32 v143, v94, v95
    buffer_store_dwordx4 v[140:143], v7, s[40:43], s57 offen offset:1024 sc1
    s_add_u32 m0, s49, 137280
    s_nop 0
    buffer_load_dwordx4 v6, s[36:39], s60 offen offset:1024 lds
    s_waitcnt vmcnt(9)
    s_barrier
    ds_read_b64_tr_b16 v[188:189], v221 offset:47168
    ds_read_b64_tr_b16 v[190:191], v221 offset:47424
    s_waitcnt lgkmcnt(6)
    v_mfma_f32_32x32x16_bf16 v[96:111], v[176:179], v[32:35], v[96:111]
    ds_read_b64_tr_b16 v[160:161], v220 offset:34304
    ds_read_b64_tr_b16 v[162:163], v220 offset:34560
    s_waitcnt lgkmcnt(6)
    v_mfma_f32_32x32x16_bf16 v[96:111], v[180:183], v[36:39], v[96:111]
    s_add_u32 s54, s76, 131072
    s_add_u32 s61, s77, 768
    s_and_b32 s54, s54, 0x30000
    s_and_b32 s61, s61, 0x300
    s_add_u32 m0, s49, 17152
    s_or_b32 s61, s61, s54
    buffer_load_dwordx4 v6, s[36:39], s61 offen offset:0 lds
    ds_read_b64_tr_b16 v[164:165], v220 offset:38592
    ds_read_b64_tr_b16 v[166:167], v220 offset:38848
    s_waitcnt lgkmcnt(6)
    v_mfma_f32_32x32x16_bf16 v[96:111], v[184:187], v[40:43], v[96:111]
    ds_read_b64_tr_b16 v[168:169], v220 offset:42880
    ds_read_b64_tr_b16 v[170:171], v220 offset:43136
    s_waitcnt lgkmcnt(6)
    v_mfma_f32_32x32x16_bf16 v[96:111], v[188:191], v[44:47], v[96:111]
    s_add_u32 m0, s49, 17216
    s_nop 0
    buffer_load_dwordx4 v6, s[36:39], s61 offen offset:1024 lds
    s_waitcnt vmcnt(9)
    s_barrier
    ds_read_b64_tr_b16 v[172:173], v220 offset:47168
    ds_read_b64_tr_b16 v[174:175], v220 offset:47424
    s_waitcnt lgkmcnt(6)
    v_mfma_f32_32x32x16_bf16 v[96:111], v[160:163], v[224:227], v[96:111]
    ds_read_b64_tr_b16 v[176:177], v222 offset:0
    ds_read_b64_tr_b16 v[178:179], v222 offset:256
    s_waitcnt lgkmcnt(6)
    v_mfma_f32_32x32x16_bf16 v[96:111], v[164:167], v[228:231], v[96:111]
    s_add_u32 s54, s76, 196608
    s_add_u32 s60, s77, 768
    s_and_b32 s54, s54, 0x30000
    s_and_b32 s60, s60, 0x300
    s_add_u32 m0, s49, 51456
    s_or_b32 s60, s60, s54
    buffer_load_dwordx4 v6, s[36:39], s60 offen offset:0 lds
    ds_read_b64_tr_b16 v[180:181], v222 offset:4288
    ds_read_b64_tr_b16 v[182:183], v222 offset:4544
    s_waitcnt lgkmcnt(6)
    v_mfma_f32_32x32x16_bf16 v[96:111], v[168:171], v[232:235], v[96:111]
    ds_read_b64_tr_b16 v[184:185], v222 offset:8576
    ds_read_b64_tr_b16 v[186:187], v222 offset:8832
    s_waitcnt lgkmcnt(6)
    v_mfma_f32_32x32x16_bf16 v[96:111], v[172:175], v[236:239], v[96:111]
    s_add_u32 m0, s49, 51520
    s_nop 0
    buffer_load_dwordx4 v6, s[36:39], s60 offen offset:1024 lds
    s_waitcnt vmcnt(9)
    s_barrier
    ds_read_b64_tr_b16 v[188:189], v222 offset:12864
    ds_read_b64_tr_b16 v[190:191], v222 offset:13120
    s_waitcnt lgkmcnt(6)
    v_mfma_f32_32x32x16_bf16 v[96:111], v[176:179], v[240:243], v[96:111]
    buffer_load_dword v12, off, s[88:91], 0 sc1
    ds_read_b64_tr_b16 v[160:161], v222 offset:17152
    ds_read_b64_tr_b16 v[162:163], v222 offset:17408
    s_waitcnt lgkmcnt(6)
    v_mfma_f32_32x32x16_bf16 v[96:111], v[180:183], v[244:247], v[96:111]
    ds_read_b64_tr_b16 v[164:165], v222 offset:21440
    ds_read_b64_tr_b16 v[166:167], v222 offset:21696
    s_waitcnt lgkmcnt(6)
    v_mfma_f32_32x32x16_bf16 v[96:111], v[184:187], v[248:251], v[96:111]
    ds_read_b64_tr_b16 v[168:169], v222 offset:25728
    ds_read_b64_tr_b16 v[170:171], v222 offset:25984
    s_waitcnt lgkmcnt(6)
    v_mfma_f32_32x32x16_bf16 v[96:111], v[188:191], v[252:255], v[96:111]
    s_waitcnt vmcnt(5)
    s_barrier
    ds_read_b64_tr_b16 v[172:173], v222 offset:30016
    ds_read_b64_tr_b16 v[174:175], v222 offset:30272
    s_waitcnt lgkmcnt(6)
    v_mfma_f32_32x32x16_bf16 v[112:127], v[160:163], v[16:19], 0
    buffer_store_dword v11, v10, s[84:87], s51 offen offset:512 sc1
    ds_read_b64_tr_b16 v[176:177], v222 offset:34304
    ds_read_b64_tr_b16 v[178:179], v222 offset:34560
    s_waitcnt lgkmcnt(6)
    v_mfma_f32_32x32x16_bf16 v[112:127], v[164:167], v[20:23], v[112:127]
    ds_read_b64_tr_b16 v[180:181], v222 offset:38592
    ds_read_b64_tr_b16 v[182:183], v222 offset:38848
    s_waitcnt lgkmcnt(6)
    v_mfma_f32_32x32x16_bf16 v[112:127], v[168:171], v[24:27], v[112:127]
    s_add_u32 s55, s77, 512
    s_and_b32 s55, s55, 0x300
    s_lshl_b32 s55, s55, 6
    s_lshl_b32 s56, s44, 11
    s_add_u32 s57, s55, s56
    v_cvt_pk_bf16_f32 v144, v96, v97
    v_cvt_pk_bf16_f32 v145, v98, v99
    v_cvt_pk_bf16_f32 v146, v100, v101
    v_cvt_pk_bf16_f32 v147, v102, v103
    buffer_store_dwordx4 v[144:147], v7, s[40:43], s57 offen offset:0 sc1
    ds_read_b64_tr_b16 v[184:185], v222 offset:42880
    ds_read_b64_tr_b16 v[186:187], v222 offset:43136
    s_waitcnt lgkmcnt(6)
    v_mfma_f32_32x32x16_bf16 v[112:127], v[172:175], v[28:31], v[112:127]
    v_cvt_pk_bf16_f32 v148, v104, v105
    v_cvt_pk_bf16_f32 v149, v106, v107
    v_cvt_pk_bf16_f32 v150, v108, v109
    v_cvt_pk_bf16_f32 v151, v110, v111
    buffer_store_dwordx4 v[148:151], v7, s[40:43], s57 offen offset:1024 sc1
    s_waitcnt vmcnt(6)
    s_barrier
    ds_read_b64_tr_b16 v[188:189], v222 offset:47168
    ds_read_b64_tr_b16 v[190:191], v222 offset:47424
    s_waitcnt lgkmcnt(6)
    v_mfma_f32_32x32x16_bf16 v[112:127], v[176:179], v[32:35], v[112:127]
    ds_read_b64_tr_b16 v[160:161], v220 offset:17152
    ds_read_b64_tr_b16 v[162:163], v220 offset:17408
    s_waitcnt lgkmcnt(6)
    v_mfma_f32_32x32x16_bf16 v[112:127], v[180:183], v[36:39], v[112:127]
    ds_read_b64_tr_b16 v[164:165], v220 offset:21440
    ds_read_b64_tr_b16 v[166:167], v220 offset:21696
    s_waitcnt lgkmcnt(6)
    v_mfma_f32_32x32x16_bf16 v[112:127], v[184:187], v[40:43], v[112:127]
    ds_read_b64_tr_b16 v[168:169], v220 offset:25728
    ds_read_b64_tr_b16 v[170:171], v220 offset:25984
    s_waitcnt lgkmcnt(6)
    v_mfma_f32_32x32x16_bf16 v[112:127], v[188:191], v[44:47], v[112:127]
    s_waitcnt vmcnt(4)
    s_barrier
    ds_read_b64_tr_b16 v[172:173], v220 offset:30016
    ds_read_b64_tr_b16 v[174:175], v220 offset:30272
    s_waitcnt lgkmcnt(6)
    v_mfma_f32_32x32x16_bf16 v[112:127], v[160:163], v[224:227], v[112:127]
    ds_read_b64_tr_b16 v[176:177], v221 offset:0
    ds_read_b64_tr_b16 v[178:179], v221 offset:256
    s_waitcnt lgkmcnt(6)
    v_mfma_f32_32x32x16_bf16 v[112:127], v[164:167], v[228:231], v[112:127]
    ds_read_b64_tr_b16 v[180:181], v221 offset:4288
    ds_read_b64_tr_b16 v[182:183], v221 offset:4544
    s_waitcnt lgkmcnt(6)
    v_mfma_f32_32x32x16_bf16 v[112:127], v[168:171], v[232:235], v[112:127]
    ds_read_b64_tr_b16 v[184:185], v221 offset:8576
    ds_read_b64_tr_b16 v[186:187], v221 offset:8832
    s_waitcnt lgkmcnt(6)
    v_mfma_f32_32x32x16_bf16 v[112:127], v[172:175], v[236:239], v[112:127]
    ds_read_b64_tr_b16 v[188:189], v221 offset:12864
    ds_read_b64_tr_b16 v[190:191], v221 offset:13120
    s_waitcnt lgkmcnt(6)
    v_mfma_f32_32x32x16_bf16 v[112:127], v[176:179], v[240:243], v[112:127]
    s_waitcnt lgkmcnt(4)
    v_mfma_f32_32x32x16_bf16 v[112:127], v[180:183], v[244:247], v[112:127]
    s_waitcnt lgkmcnt(2)
    v_mfma_f32_32x32x16_bf16 v[112:127], v[184:187], v[248:251], v[112:127]
    s_waitcnt lgkmcnt(0)
    v_mfma_f32_32x32x16_bf16 v[112:127], v[188:191], v[252:255], v[112:127]
    s_add_u32 s55, s77, 768
    s_and_b32 s55, s55, 0x300
    s_lshl_b32 s55, s55, 6
    s_lshl_b32 s56, s44, 11
    s_add_u32 s57, s55, s56
    s_nop 6
    v_cvt_pk_bf16_f32 v152, v112, v113
    v_cvt_pk_bf16_f32 v153, v114, v115
    v_cvt_pk_bf16_f32 v154, v116, v117
    v_cvt_pk_bf16_f32 v155, v118, v119
    buffer_store_dwordx4 v[152:155], v7, s[40:43], s57 offen offset:0 sc1
    v_cvt_pk_bf16_f32 v156, v120, v121
    v_cvt_pk_bf16_f32 v157, v122, v123
    v_cvt_pk_bf16_f32 v158, v124, v125
    v_cvt_pk_bf16_f32 v159, v126, v127
    buffer_store_dwordx4 v[156:159], v7, s[40:43], s57 offen offset:1024 sc1
    s_mov_b32 s55, 0
    s_waitcnt vmcnt(2)
    buffer_store_dword v11, v10, s[84:87], s51 offen offset:1024 sc1
    s_waitcnt vmcnt(1)
    buffer_store_dword v11, v10, s[84:87], s51 offen offset:1536 sc1
    s_cmp_ge_u32 s44, 4
    s_cbranch_scc1 L_MAIN_END
L_CNT:
    v_cmp_gt_u32 vcc, 16, v12
    s_add_u32 s55, s55, 1
    s_nop 2
    s_cbranch_vccz L_POLL
    s_cmp_gt_u32 s55, 0x40000
    s_cbranch_scc1 L_POLL
    s_sleep 4
    buffer_load_dword v12, off, s[88:91], 0 sc1
    s_waitcnt vmcnt(0)
    s_branch L_CNT
L_POLL:
    buffer_load_dword v8, v14, s[84:87], s82 offen sc1
    s_add_u32 s55, s55, 1
    s_waitcnt vmcnt(0)
    v_cmp_ne_u32 vcc, v11, v8
    s_cmp_gt_u32 s55, 0x40000
    s_nop 2
    s_cbranch_vccz L_GO
    s_cbranch_scc1 L_GO
    s_sleep 1
    s_branch L_POLL
L_GO:
    buffer_load_dwordx4 v[64:67], v13, s[92:95], s4 offen sc1
    buffer_load_dwordx4 v[68:71], v13, s[92:95], s5 offen sc1
    buffer_load_dwordx4 v[72:75], v13, s[92:95], s6 offen sc1
    buffer_load_dwordx4 v[76:79], v13, s[92:95], s7 offen sc1
    buffer_load_dwordx4 v[80:83], v13, s[92:95], s8 offen sc1
    buffer_load_dwordx4 v[84:87], v13, s[92:95], s9 offen sc1
    buffer_load_dwordx4 v[88:91], v13, s[92:95], s10 offen sc1
    buffer_load_dwordx4 v[92:95], v13, s[92:95], s11 offen sc1
    buffer_load_dwordx4 v[96:99], v13, s[92:95], s12 offen sc1
    buffer_load_dwordx4 v[100:103], v13, s[92:95], s13 offen sc1
    buffer_load_dwordx4 v[104:107], v13, s[92:95], s14 offen sc1
    buffer_load_dwordx4 v[108:111], v13, s[92:95], s15 offen sc1
    buffer_load_dwordx4 v[112:115], v13, s[92:95], s16 offen sc1
    buffer_load_dwordx4 v[116:119], v13, s[92:95], s17 offen sc1
    buffer_load_dwordx4 v[120:123], v13, s[92:95], s18 offen sc1
    buffer_load_dwordx4 v[124:127], v13, s[92:95], s19 offen sc1
    s_mov_b32 s55, 0xffff0000
    s_waitcnt vmcnt(15)
    v_lshlrev_b32 v16, 16, v64
    v_and_b32 v17, s55, v64
    v_lshlrev_b32 v18, 16, v65
    v_and_b32 v19, s55, v65
    v_lshlrev_b32 v20, 16, v66
    v_and_b32 v21, s55, v66
    v_lshlrev_b32 v22, 16, v67
    v_and_b32 v23, s55, v67
    s_waitcnt vmcnt(14)
    v_lshlrev_b32 v32, 16, v68
    v_and_b32 v33, s55, v68
    v_add_f32 v16, v16, v32
    v_add_f32 v17, v17, v33
    v_lshlrev_b32 v34, 16, v69
    v_and_b32 v35, s55, v69
    v_add_f32 v18, v18, v34
    v_add_f32 v19, v19, v35
    v_lshlrev_b32 v36, 16, v70
    v_and_b32 v37, s55, v70
    v_add_f32 v20, v20, v36
    v_add_f32 v21, v21, v37
    v_lshlrev_b32 v38, 16, v71
    v_and_b32 v39, s55, v71
    v_add_f32 v22, v22, v38
    v_add_f32 v23, v23, v39
    s_waitcnt vmcnt(13)
    v_lshlrev_b32 v32, 16, v72
    v_and_b32 v33, s55, v72
    v_add_f32 v16, v16, v32
    v_add_f32 v17, v17, v33
    v_lshlrev_b32 v34, 16, v73
    v_and_b32 v35, s55, v73
    v_add_f32 v18, v18, v34
    v_add_f32 v19, v19, v35
    v_lshlrev_b32 v36, 16, v74
    v_and_b32 v37, s55, v74
    v_add_f32 v20, v20, v36
    v_add_f32 v21, v21, v37
    v_lshlrev_b32 v38, 16, v75
    v_and_b32 v39, s55, v75
    v_add_f32 v22, v22, v38
    v_add_f32 v23, v23, v39
    s_waitcnt vmcnt(12)
    v_lshlrev_b32 v32, 16, v76
    v_and_b32 v33, s55, v76
    v_add_f32 v16, v16, v32
    v_add_f32 v17, v17, v33
    v_lshlrev_b32 v34, 16, v77
    v_and_b32 v35, s55, v77
    v_add_f32 v18, v18, v34
    v_add_f32 v19, v19, v35
    v_lshlrev_b32 v36, 16, v78
    v_and_b32 v37, s55, v78
    v_add_f32 v20, v20, v36
    v_add_f32 v21, v21, v37
    v_lshlrev_b32 v38, 16, v79
    v_and_b32 v39, s55, v79
    v_add_f32 v22, v22, v38
    v_add_f32 v23, v23, v39
    s_waitcnt vmcnt(11)
    v_lshlrev_b32 v32, 16, v80
    v_and_b32 v33, s55, v80
    v_add_f32 v16, v16, v32
    v_add_f32 v17, v17, v33
    v_lshlrev_b32 v34, 16, v81
    v_and_b32 v35, s55, v81
    v_add_f32 v18, v18, v34
    v_add_f32 v19, v19, v35
    v_lshlrev_b32 v36, 16, v82
    v_and_b32 v37, s55, v82
    v_add_f32 v20, v20, v36
    v_add_f32 v21, v21, v37
    v_lshlrev_b32 v38, 16, v83
    v_and_b32 v39, s55, v83
    v_add_f32 v22, v22, v38
    v_add_f32 v23, v23, v39
    s_waitcnt vmcnt(10)
    v_lshlrev_b32 v32, 16, v84
    v_and_b32 v33, s55, v84
    v_add_f32 v16, v16, v32
    v_add_f32 v17, v17, v33
    v_lshlrev_b32 v34, 16, v85
    v_and_b32 v35, s55, v85
    v_add_f32 v18, v18, v34
    v_add_f32 v19, v19, v35
    v_lshlrev_b32 v36, 16, v86
    v_and_b32 v37, s55, v86
    v_add_f32 v20, v20, v36
    v_add_f32 v21, v21, v37
    v_lshlrev_b32 v38, 16, v87
    v_and_b32 v39, s55, v87
    v_add_f32 v22, v22, v38
    v_add_f32 v23, v23, v39
    s_waitcnt vmcnt(9)
    v_lshlrev_b32 v32, 16, v88
    v_and_b32 v33, s55, v88
    v_add_f32 v16, v16, v32
    v_add_f32 v17, v17, v33
    v_lshlrev_b32 v34, 16, v89
    v_and_b32 v35, s55, v89
    v_add_f32 v18, v18, v34
    v_add_f32 v19, v19, v35
    v_lshlrev_b32 v36, 16, v90
    v_and_b32 v37, s55, v90
    v_add_f32 v20, v20, v36
    v_add_f32 v21, v21, v37
    v_lshlrev_b32 v38, 16, v91
    v_and_b32 v39, s55, v91
    v_add_f32 v22, v22, v38
    v_add_f32 v23, v23, v39
    s_waitcnt vmcnt(8)
    v_lshlrev_b32 v32, 16, v92
    v_and_b32 v33, s55, v92
    v_add_f32 v16, v16, v32
    v_add_f32 v17, v17, v33
    v_lshlrev_b32 v34, 16, v93
    v_and_b32 v35, s55, v93
    v_add_f32 v18, v18, v34
    v_add_f32 v19, v19, v35
    v_lshlrev_b32 v36, 16, v94
    v_and_b32 v37, s55, v94
    v_add_f32 v20, v20, v36
    v_add_f32 v21, v21, v37
    v_lshlrev_b32 v38, 16, v95
    v_and_b32 v39, s55, v95
    v_add_f32 v22, v22, v38
    v_add_f32 v23, v23, v39
    s_waitcnt vmcnt(7)
    v_lshlrev_b32 v32, 16, v96
    v_and_b32 v33, s55, v96
    v_add_f32 v16, v16, v32
    v_add_f32 v17, v17, v33
    v_lshlrev_b32 v34, 16, v97
    v_and_b32 v35, s55, v97
    v_add_f32 v18, v18, v34
    v_add_f32 v19, v19, v35
    v_lshlrev_b32 v36, 16, v98
    v_and_b32 v37, s55, v98
    v_add_f32 v20, v20, v36
    v_add_f32 v21, v21, v37
    v_lshlrev_b32 v38, 16, v99
    v_and_b32 v39, s55, v99
    v_add_f32 v22, v22, v38
    v_add_f32 v23, v23, v39
    s_waitcnt vmcnt(6)
    v_lshlrev_b32 v32, 16, v100
    v_and_b32 v33, s55, v100
    v_add_f32 v16, v16, v32
    v_add_f32 v17, v17, v33
    v_lshlrev_b32 v34, 16, v101
    v_and_b32 v35, s55, v101
    v_add_f32 v18, v18, v34
    v_add_f32 v19, v19, v35
    v_lshlrev_b32 v36, 16, v102
    v_and_b32 v37, s55, v102
    v_add_f32 v20, v20, v36
    v_add_f32 v21, v21, v37
    v_lshlrev_b32 v38, 16, v103
    v_and_b32 v39, s55, v103
    v_add_f32 v22, v22, v38
    v_add_f32 v23, v23, v39
    s_waitcnt vmcnt(5)
    v_lshlrev_b32 v32, 16, v104
    v_and_b32 v33, s55, v104
    v_add_f32 v16, v16, v32
    v_add_f32 v17, v17, v33
    v_lshlrev_b32 v34, 16, v105
    v_and_b32 v35, s55, v105
    v_add_f32 v18, v18, v34
    v_add_f32 v19, v19, v35
    v_lshlrev_b32 v36, 16, v106
    v_and_b32 v37, s55, v106
    v_add_f32 v20, v20, v36
    v_add_f32 v21, v21, v37
    v_lshlrev_b32 v38, 16, v107
    v_and_b32 v39, s55, v107
    v_add_f32 v22, v22, v38
    v_add_f32 v23, v23, v39
    s_waitcnt vmcnt(4)
    v_lshlrev_b32 v32, 16, v108
    v_and_b32 v33, s55, v108
    v_add_f32 v16, v16, v32
    v_add_f32 v17, v17, v33
    v_lshlrev_b32 v34, 16, v109
    v_and_b32 v35, s55, v109
    v_add_f32 v18, v18, v34
    v_add_f32 v19, v19, v35
    v_lshlrev_b32 v36, 16, v110
    v_and_b32 v37, s55, v110
    v_add_f32 v20, v20, v36
    v_add_f32 v21, v21, v37
    v_lshlrev_b32 v38, 16, v111
    v_and_b32 v39, s55, v111
    v_add_f32 v22, v22, v38
    v_add_f32 v23, v23, v39
    s_waitcnt vmcnt(3)
    v_lshlrev_b32 v32, 16, v112
    v_and_b32 v33, s55, v112
    v_add_f32 v16, v16, v32
    v_add_f32 v17, v17, v33
    v_lshlrev_b32 v34, 16, v113
    v_and_b32 v35, s55, v113
    v_add_f32 v18, v18, v34
    v_add_f32 v19, v19, v35
    v_lshlrev_b32 v36, 16, v114
    v_and_b32 v37, s55, v114
    v_add_f32 v20, v20, v36
    v_add_f32 v21, v21, v37
    v_lshlrev_b32 v38, 16, v115
    v_and_b32 v39, s55, v115
    v_add_f32 v22, v22, v38
    v_add_f32 v23, v23, v39
    s_waitcnt vmcnt(2)
    v_lshlrev_b32 v32, 16, v116
    v_and_b32 v33, s55, v116
    v_add_f32 v16, v16, v32
    v_add_f32 v17, v17, v33
    v_lshlrev_b32 v34, 16, v117
    v_and_b32 v35, s55, v117
    v_add_f32 v18, v18, v34
    v_add_f32 v19, v19, v35
    v_lshlrev_b32 v36, 16, v118
    v_and_b32 v37, s55, v118
    v_add_f32 v20, v20, v36
    v_add_f32 v21, v21, v37
    v_lshlrev_b32 v38, 16, v119
    v_and_b32 v39, s55, v119
    v_add_f32 v22, v22, v38
    v_add_f32 v23, v23, v39
    s_waitcnt vmcnt(1)
    v_lshlrev_b32 v32, 16, v120
    v_and_b32 v33, s55, v120
    v_add_f32 v16, v16, v32
    v_add_f32 v17, v17, v33
    v_lshlrev_b32 v34, 16, v121
    v_and_b32 v35, s55, v121
    v_add_f32 v18, v18, v34
    v_add_f32 v19, v19, v35
    v_lshlrev_b32 v36, 16, v122
    v_and_b32 v37, s55, v122
    v_add_f32 v20, v20, v36
    v_add_f32 v21, v21, v37
    v_lshlrev_b32 v38, 16, v123
    v_and_b32 v39, s55, v123
    v_add_f32 v22, v22, v38
    v_add_f32 v23, v23, v39
    s_waitcnt vmcnt(0)
    v_lshlrev_b32 v32, 16, v124
    v_and_b32 v33, s55, v124
    v_add_f32 v16, v16, v32
    v_add_f32 v17, v17, v33
    v_lshlrev_b32 v34, 16, v125
    v_and_b32 v35, s55, v125
    v_add_f32 v18, v18, v34
    v_add_f32 v19, v19, v35
    v_lshlrev_b32 v36, 16, v126
    v_and_b32 v37, s55, v126
    v_add_f32 v20, v20, v36
    v_add_f32 v21, v21, v37
    v_lshlrev_b32 v38, 16, v127
    v_and_b32 v39, s55, v127
    v_add_f32 v22, v22, v38
    v_add_f32 v23, v23, v39
    v_cvt_pk_bf16_f32 v40, v16, v17
    v_cvt_pk_bf16_f32 v41, v18, v19
    v_cvt_pk_bf16_f32 v42, v20, v21
    v_cvt_pk_bf16_f32 v43, v22, v23
    buffer_store_dwordx4 v[40:43], v15, s[96:99], s81 offen
L_MAIN_END:
    s_endpgm
L_FALLBACK:
    s_waitcnt vmcnt(0) lgkmcnt(0)
    s_nop 15
    s_barrier
    s_add_u32 s61, s70, 0
    s_add_u32 m0, s48, 51456
    s_and_b32 s61, s61, 0x1ffff
    buffer_load_dwordx4 v4, s[28:31], s61 offen offset:0 nt lds
    s_add_u32 m0, s48, 52240
    s_nop 0
    buffer_load_dwordx4 v4, s[28:31], s61 offen offset:256 nt lds
    s_add_u32 s60, s75, 8192
    s_add_u32 m0, s48, 85760
    s_and_b32 s60, s60, 0x1ffff
    buffer_load_dwordx4 v4, s[28:31], s60 offen offset:0 nt lds
    s_add_u32 m0, s48, 86544
    s_nop 0
    buffer_load_dwordx4 v4, s[28:31], s60 offen offset:256 nt lds
    v_and_b32 v10, 31, v1
    v_lshlrev_b32 v10, 8, v10
    v_lshrrev_b32 v11, 5, v1
    v_lshl_add_u32 v10, v11, 4, v10
    s_mul_i32 s54, s45, 131200
    s_mul_i32 s55, s45, 130944
    s_add_u32 s55, s55, 128
    v_add_u32 v11, s55, v10
    v_add_u32 v10, s54, v10
    v_mov_b32 v0, 0xff800000
    s_mov_b32 s56, 0
L_FB_LOOP:
    buffer_load_dwordx4 v[160:163], v10, s[28:31], s56 offen offset:0
    buffer_load_dwordx4 v[164:167], v10, s[28:31], s56 offen offset:32
    buffer_load_dwordx4 v[168:171], v10, s[28:31], s56 offen offset:64
    buffer_load_dwordx4 v[172:175], v10, s[28:31], s56 offen offset:96
    buffer_load_dwordx4 v[176:179], v11, s[28:31], s56 offen offset:0
    buffer_load_dwordx4 v[180:183], v11, s[28:31], s56 offen offset:32
    buffer_load_dwordx4 v[184:187], v11, s[28:31], s56 offen offset:64
    buffer_load_dwordx4 v[188:191], v11, s[28:31], s56 offen offset:96
    s_waitcnt vmcnt(7)
    v_mfma_f32_32x32x16_bf16 v[128:143], v[160:163], v[16:19], 0
    s_waitcnt vmcnt(6)
    v_mfma_f32_32x32x16_bf16 v[128:143], v[164:167], v[20:23], v[128:143]
    s_waitcnt vmcnt(5)
    v_mfma_f32_32x32x16_bf16 v[128:143], v[168:171], v[24:27], v[128:143]
    s_waitcnt vmcnt(4)
    v_mfma_f32_32x32x16_bf16 v[128:143], v[172:175], v[28:31], v[128:143]
    s_waitcnt vmcnt(3)
    v_mfma_f32_32x32x16_bf16 v[128:143], v[176:179], v[32:35], v[128:143]
    s_waitcnt vmcnt(2)
    v_mfma_f32_32x32x16_bf16 v[128:143], v[180:183], v[36:39], v[128:143]
    s_waitcnt vmcnt(1)
    v_mfma_f32_32x32x16_bf16 v[128:143], v[184:187], v[40:43], v[128:143]
    s_waitcnt vmcnt(0)
    v_mfma_f32_32x32x16_bf16 v[128:143], v[188:191], v[44:47], v[128:143]
    s_nop 11
    v_max3_f32 v0, v0, v128, v129
    v_max3_f32 v0, v0, v130, v131
    v_max3_f32 v0, v0, v132, v133
    v_max3_f32 v0, v0, v134, v135
    v_max3_f32 v0, v0, v136, v137
    v_max3_f32 v0, v0, v138, v139
    v_max3_f32 v0, v0, v140, v141
    v_max3_f32 v0, v0, v142, v143
    s_add_u32 s56, s56, 8192
    s_cmp_lt_u32 s56, 131072
    s_nop 7
    s_cbranch_scc1 L_FB_LOOP
    v_mov_b32 v11, v0
    s_nop 1
    v_permlane32_swap_b32 v0, v11
    v_max_f32 v0, v0, v11
    s_mov_b64 s[52:53], -1
    s_waitcnt vmcnt(0) lgkmcnt(0)
    s_barrier
    ds_read_b128 v[160:163], v209 offset:0
    ds_read_b128 v[164:167], v209 offset:32
    ds_read_b128 v[168:171], v209 offset:64
    ds_read_b128 v[172:175], v209 offset:96
    ds_read_b128 v[176:179], v209 offset:34304
    ds_read_b128 v[180:183], v209 offset:34336
    ds_read_b128 v[184:187], v209 offset:34368
    s_waitcnt lgkmcnt(6)
    v_mfma_f32_32x32x16_bf16 v[128:143], v[160:163], v[16:19], 0
    ds_read_b128 v[188:191], v209 offset:34400
    s_waitcnt lgkmcnt(6)
    v_mfma_f32_32x32x16_bf16 v[128:143], v[164:167], v[20:23], v[128:143]
    s_waitcnt lgkmcnt(4)
    v_mfma_f32_32x32x16_bf16 v[128:143], v[168:171], v[24:27], v[128:143]
    v_mfma_f32_32x32x16_bf16 v[128:143], v[172:175], v[28:31], v[128:143]
    s_waitcnt lgkmcnt(2)
    v_mfma_f32_32x32x16_bf16 v[144:159], v[176:179], v[16:19], 0
    v_mfma_f32_32x32x16_bf16 v[144:159], v[180:183], v[20:23], v[144:159]
    s_waitcnt lgkmcnt(0)
    v_mfma_f32_32x32x16_bf16 v[144:159], v[184:187], v[24:27], v[144:159]
    v_mfma_f32_32x32x16_bf16 v[144:159], v[188:191], v[28:31], v[144:159]
    ds_read_b128 v[160:163], v212 offset:0
    ds_read_b128 v[164:167], v212 offset:32
    ds_read_b128 v[168:171], v212 offset:64
    ds_read_b128 v[172:175], v212 offset:96
    ds_read_b128 v[176:179], v212 offset:34304
    ds_read_b128 v[180:183], v212 offset:34336
    s_waitcnt lgkmcnt(0)
    s_barrier
    s_add_u32 s61, s70, 0
    s_add_u32 m0, s49, 102912
    s_and_b32 s61, s61, 0x1ffff
    buffer_load_dwordx4 v5, s[32:35], s61 offen offset:0 nt lds
    s_add_u32 m0, s49, 103744
    s_nop 0
    buffer_load_dwordx4 v5, s[32:35], s61 offen offset:256 nt lds
    s_add_u32 s60, s70, 16384
    s_add_u32 m0, s48, 120064
    s_and_b32 s60, s60, 0x1ffff
    buffer_load_dwordx4 v4, s[28:31], s60 offen offset:0 nt lds
    s_add_u32 m0, s48, 120848
    s_nop 0
    buffer_load_dwordx4 v4, s[28:31], s60 offen offset:256 nt lds
    s_add_u32 s61, s75, 8192
    s_add_u32 m0, s49, 137216
    s_and_b32 s61, s61, 0x1ffff
    buffer_load_dwordx4 v5, s[32:35], s61 offen offset:0 nt lds
    s_add_u32 m0, s49, 138048
    s_nop 0
    buffer_load_dwordx4 v5, s[32:35], s61 offen offset:256 nt lds
    s_add_u32 s60, s75, 24576
    s_add_u32 m0, s48, 17152
    s_and_b32 s60, s60, 0x1ffff
    buffer_load_dwordx4 v4, s[28:31], s60 offen offset:0 nt lds
    s_add_u32 m0, s48, 17936
    s_nop 0
    buffer_load_dwordx4 v4, s[28:31], s60 offen offset:256 nt lds
    s_add_u32 s61, s70, 16384
    s_add_u32 m0, s49, 0
    s_and_b32 s61, s61, 0x1ffff
    buffer_load_dwordx4 v5, s[32:35], s61 offen offset:0 nt lds
    s_add_u32 m0, s49, 832
    s_nop 0
    buffer_load_dwordx4 v5, s[32:35], s61 offen offset:256 nt lds
    s_waitcnt vmcnt(0)
    s_barrier
    s_nop 15
    s_branch L_ATTN2
L_RED_END:
    s_endpgm
.section .rodata,"a"
.p2align 6
.amdhsa_kernel standalone__gqa_block_cached__near_ridge_kernel
  .amdhsa_next_free_vgpr 256
  .amdhsa_next_free_sgpr 102
  .amdhsa_accum_offset 256
  .amdhsa_group_segment_fixed_size 0
  .amdhsa_kernarg_size 64
  .amdhsa_user_sgpr_count 2
  .amdhsa_user_sgpr_kernarg_segment_ptr 1
  .amdhsa_system_sgpr_workgroup_id_x 1
.end_amdhsa_kernel
```
